```python
import torch

def _softmax(x, axis=-1):
    return torch.softmax(x, dim=axis)
def _gelu(x):
    return torch.nn.functional.gelu(x, approximate="tanh")
def _silu(x):
    return torch.nn.functional.silu(x)
def _sigmoid(x):
    return torch.sigmoid(x)
def _layernorm(x, axis=-1, eps=1e-5):
    m = x.mean(dim=axis, keepdim=True)
    v = x.var(dim=axis, keepdim=True, unbiased=False)
    return (x - m) / torch.sqrt(v + eps)
def _scatter_add(tgt, idx, src, axis=0):
    return tgt.clone().index_add_(axis, idx, src)
def _segment_sum(src, seg, n):
    out = torch.zeros((n,) + src.shape[1:], dtype=src.dtype)
    return out.index_add_(0, seg, src)
def _pad(x, pw):
    flat = tuple(v for pair in reversed(pw) for v in pair)
    return torch.nn.functional.pad(x, flat)

kernel_name = 'sequential_preLN__mha_block_cached__glu_gated_geglu__decode'

def setup_inputs():

    _w = (lambda a: (lambda t: t.to(torch.bfloat16) if t.is_floating_point() else t)(torch.as_tensor(a)))
    def _A_setup():
        B, Sq, D = 4, 1, 576
        H, Sk, Dh = 32, 8192, 128
        return {
            "x": _w((lambda *s: torch.randn(*s, dtype=torch.bfloat16) * 0.05)(B, Sq, D)),
            "k_cache": _w((lambda *s: torch.randn(*s, dtype=torch.bfloat16) * 1.6)(B, H, Sk, Dh)),
            "v_cache": _w((lambda *s: torch.randn(*s, dtype=torch.bfloat16) * 0.8)(B, H, Sk, Dh)),
            "wq": _w((lambda *s: torch.randn(*s, dtype=torch.bfloat16) * 1.6)(D, H * Dh) * (D ** -0.5)),
            "wo": _w((lambda *s: torch.randn(*s, dtype=torch.bfloat16) * 0.8)(H * Dh, D) * ((H * Dh) ** -0.5)),
        }
    _A_in = _A_setup()

    def _B_setup():
        B, S, Dm, Df = 4, 1, 576, 4608
        return {
            "x": _w((lambda *s: torch.randn(*s, dtype=torch.bfloat16) * 0.05)(B, S, Dm)),
            "w_gate": _w((lambda *s: torch.randn(*s, dtype=torch.bfloat16) * 0.8)(Dm, Df) * (Dm ** -0.5)),
            "w_up": _w((lambda *s: torch.randn(*s, dtype=torch.bfloat16) * 0.8)(Dm, Df) * (Dm ** -0.5)),
            "w_down": _w((lambda *s: torch.randn(*s, dtype=torch.bfloat16) * 0.8)(Df, Dm) * (Df ** -0.5)),
        }
    _B_in = _B_setup()

    return {
        "A_x": _A_in["x"],
        "A_k_cache": _A_in["k_cache"],
        "A_v_cache": _A_in["v_cache"],
        "A_wq": _A_in["wq"],
        "A_wo": _A_in["wo"],
        "B_x": _B_in["x"],
        "B_w_gate": _B_in["w_gate"],
        "B_w_up": _B_in["w_up"],
        "B_w_down": _B_in["w_down"],
    }

def reference(A_x, A_k_cache, A_v_cache, A_wq, A_wo, B_x, B_w_gate, B_w_up, B_w_down):
    def _A_ref(x, k_cache, v_cache, wq, wo):
        B, Sq, D = x.shape
        H, Dh = 32, 128
        q = (lambda x, *d: x.permute(*d))((x @ wq).reshape(B, Sq, H, Dh), 0, 2, 1, 3)
        scores = torch.einsum("bhqd,bhkd->bhqk", q, k_cache) * (Dh ** -0.5)
        p = _softmax(scores, axis=-1)
        o = torch.einsum("bhqk,bhkd->bhqd", p, v_cache)
        return (lambda x, *d: x.permute(*d))(o, 0, 2, 1, 3).reshape(B, Sq, H * Dh) @ wo

    def _B_ref(x, w_gate, w_up, w_down):
        g = torch.einsum("bsd,df->bsf", x, w_gate)
        u = torch.einsum("bsd,df->bsf", x, w_up)
        h = _gelu(g) * u
        return torch.einsum("bsf,fd->bsd", h, w_down)

    x = A_x
    h = x + _A_ref(_layernorm(x, axis=-1), A_k_cache, A_v_cache, A_wq, A_wo)
    h2 = h + _B_ref(_layernorm(h, axis=-1), B_w_gate, B_w_up, B_w_down)
    return h2
```

```asm
; @launch grid=(256,1,1) block=(512,1,1) lds=149504
.amdgcn_target "amdgcn-amd-amdhsa--gfx950"
.text
.globl sequential_preLN__mha_block_cached__glu_gated_geglu__decode_kernel
.p2align 8
.type sequential_preLN__mha_block_cached__glu_gated_geglu__decode_kernel,@function
sequential_preLN__mha_block_cached__glu_gated_geglu__decode_kernel:
    s_cmp_ge_u32 s2, 256
    s_cbranch_scc1 L_end
    s_load_dwordx16 s[64:79], s[0:1], 0
    s_load_dwordx8 s[80:87], s[0:1], 64
    v_lshrrev_b32 v1, 6, v0
    s_nop 0
    v_readfirstlane_b32 s3, v1
    v_and_b32 v2, 63, v0
    v_and_b32 v3, 15, v2
    v_lshrrev_b32 v4, 4, v2
    s_and_b32 s88, s2, 7
    s_lshr_b32 s89, s2, 3
    s_and_b32 s90, s89, 3
    s_lshl_b32 s48, s88, 2
    s_add_u32 s48, s48, s90
    s_lshr_b32 s49, s89, 2
    s_mul_i32 s53, s88, 18
    s_add_u32 s53, s53, s89
    s_cmp_lt_u32 s89, 18
    s_cselect_b32 s53, s53, 255
    s_lshr_b32 s52, s89, 4
    s_and_b32 s90, s89, 15
    s_cmp_ge_u32 s90, 14
    s_cselect_b32 s91, 14, 0
    s_sub_u32 s92, s90, s91
    s_cmp_ge_u32 s92, 7
    s_cselect_b32 s91, 7, 0
    s_sub_u32 s92, s92, s91
    s_add_u32 s92, s92, 1
    s_mul_i32 s92, s92, s52
    s_xor_b32 s92, s92, s88
    s_lshl_b32 s54, s90, 3
    s_add_u32 s54, s54, s92
    s_lshr_b32 s50, s54, 5
    s_and_b32 s51, s54, 31
    v_lshlrev_b32 v128, 8, v3
    v_lshl_add_u32 v128, v4, 4, v128
    v_lshlrev_b32 v129, 10, v4
    v_lshl_add_u32 v129, v3, 4, v129
    s_mov_b32 s59, 0xfffffffe
    s_mov_b32 s61, 255
    s_mov_b32 s97, -1
    s_mov_b32 s100, 0
    v_mov_b32 v133, 4224
    v_mov_b32 v132, 1
    v_mov_b32 v141, 0
    v_lshrrev_b32 v5, 1, v2
    v_lshlrev_b32 v5, 13, v5
    v_and_b32 v6, 1, v2
    v_lshl_add_u32 v5, v6, 4, v5
    s_waitcnt lgkmcnt(0)
    s_mov_b32 s20, s86
    s_mov_b32 s21, s87
    s_mov_b32 s22, 0x400000
    s_mov_b32 s23, 0x20000
    s_mov_b32 s4, s64
    s_mov_b32 s5, s65
    s_mov_b32 s6, 0x1200
    s_mov_b32 s7, 0x20000
    s_lshl_b32 s88, s48, 8
    s_lshl_b32 s89, s49, 5
    s_add_u32 s88, s88, s89
    s_sub_u32 s89, 4718592, s88
    s_add_u32 s16, s70, s88
    s_addc_u32 s17, s71, 0
    s_mov_b32 s18, s89
    s_mov_b32 s19, 0x20000
    s_mov_b32 s88, 0x1f8000
    buffer_load_dword v221, v141, s[20:23], s88 offen sc1
    s_cmp_lt_u32 s3, 4
    s_cbranch_scc0 L_nox_1
    s_mul_i32 s88, s3, 1152
    v_lshlrev_b32 v6, 2, v2
    buffer_load_dword v216, v6, s[4:7], s88 offen offset:0
    buffer_load_dword v217, v6, s[4:7], s88 offen offset:256
    buffer_load_dword v218, v6, s[4:7], s88 offen offset:512
    buffer_load_dword v219, v6, s[4:7], s88 offen offset:768
    buffer_load_dword v220, v6, s[4:7], s88 offen offset:1024
L_nox_1:
    s_add_u32 s88, s3, 0
    s_lshl_b32 s89, s88, 18
    s_lshl_b32 s88, s88, 10
    s_add_u32 m0, s88, 19968
    s_nop 0
    buffer_load_dwordx4 v5, s[16:19], s89 offen lds
    s_add_u32 s88, s3, 8
    s_lshl_b32 s89, s88, 18
    s_lshl_b32 s88, s88, 10
    s_add_u32 m0, s88, 19968
    s_nop 0
    buffer_load_dwordx4 v5, s[16:19], s89 offen lds
    s_cmp_lt_u32 s3, 2
    s_cbranch_scc0 L_wqd_4
    s_add_u32 s88, s3, 16
    s_lshl_b32 s89, s88, 18
    s_lshl_b32 s88, s88, 10
    s_add_u32 m0, s88, 19968
    s_nop 0
    buffer_load_dwordx4 v5, s[16:19], s89 offen lds
L_wqd_4:
    s_lshl_b32 s88, s54, 21
    s_add_u32 s8, s66, s88
    s_addc_u32 s9, s67, 0
    s_mov_b32 s10, 0x200000
    s_mov_b32 s11, 0x20000
    s_add_u32 s12, s68, s88
    s_addc_u32 s13, s69, 0
    s_mov_b32 s14, 0x200000
    s_mov_b32 s15, 0x20000
    s_cmp_eq_u32 s3, 0
    s_cbranch_scc1 L_nokv_5
    s_add_u32 s55, s3, 7
    s_lshr_b32 s88, s55, 3
    s_lshl_b32 s88, s88, 4
    s_and_b32 s89, s55, 7
    s_add_u32 s88, s88, s89
    s_lshl_b32 s89, s52, 3
    s_add_u32 s88, s88, s89
    s_lshl_b32 s56, s88, 12
    buffer_load_dwordx4 v[48:51], v128, s[8:11], s56 offen offset:0 nt
    buffer_load_dwordx4 v[52:55], v128, s[8:11], s56 offen offset:64 nt
    buffer_load_dwordx4 v[56:59], v128, s[8:11], s56 offen offset:128 nt
    buffer_load_dwordx4 v[60:63], v128, s[8:11], s56 offen offset:192 nt
    buffer_load_dwordx4 v[64:67], v129, s[12:15], s56 offen offset:0 nt
    buffer_load_dwordx4 v[68:71], v129, s[12:15], s56 offen offset:256 nt
    buffer_load_dwordx4 v[72:75], v129, s[12:15], s56 offen offset:512 nt
    buffer_load_dwordx4 v[76:79], v129, s[12:15], s56 offen offset:768 nt
L_nokv_5:
    s_mov_b32 s24, s72
    s_mov_b32 s25, s73
    s_mov_b32 s26, 0x480000
    s_mov_b32 s27, 0x20000
    s_mov_b32 s28, s76
    s_mov_b32 s29, s77
    s_mov_b32 s30, 0x510000
    s_mov_b32 s31, 0x20000
    s_mov_b32 s32, s78
    s_mov_b32 s33, s79
    s_mov_b32 s34, 0x510000
    s_mov_b32 s35, 0x20000
    s_mov_b32 s36, s80
    s_mov_b32 s37, s81
    s_mov_b32 s38, 0x510000
    s_mov_b32 s39, 0x20000
    s_mov_b32 s40, s82
    s_mov_b32 s41, s83
    s_mov_b32 s42, 0x1200
    s_mov_b32 s43, 0x20000
    s_mov_b32 s44, s84
    s_mov_b32 s45, s85
    s_mov_b32 s46, 0x100
    s_mov_b32 s47, 0x20000
    s_lshr_b32 s88, s2, 3
    s_and_b32 s89, s88, 0x1e
    s_cmp_eq_u32 s89, 20
    s_cselect_b32 s76, 4, 2
    s_cmp_lt_u32 s88, 18
    s_cselect_b32 s76, 0, s76
    v_and_b32 v24, 1, v3
    v_cmp_eq_u32 vcc, 1, v24
    v_mov_b32 v24, 0xffff
    v_mov_b32 v25, 0xffff0000
    v_cndmask_b32 v24, v24, v25, vcc
    v_lshrrev_b32 v25, 1, v3
    v_cmp_eq_u32 vcc, 0, v25
    s_nop 1
    v_cndmask_b32 v28, 0, v24, vcc
    v_cmp_eq_u32 vcc, 1, v25
    s_nop 1
    v_cndmask_b32 v29, 0, v24, vcc
    v_cmp_eq_u32 vcc, 2, v25
    s_nop 1
    v_cndmask_b32 v30, 0, v24, vcc
    v_cmp_eq_u32 vcc, 3, v25
    s_nop 1
    v_cndmask_b32 v31, 0, v24, vcc
    s_cmp_eq_u32 s3, 7
    s_cbranch_scc0 L_ci_6
    v_mov_b32 v8, 15
    v_mov_b32 v9, 0
    v_mov_b32 v10, 0
    v_mov_b32 v11, 0
    s_mov_b64 exec, 1
    ds_write_b128 v133, v[8:11]
    v_mov_b32 v8, 0
    ds_write_b128 v133, v[8:11] offset:16
    ds_write_b128 v133, v[8:11] offset:32
    s_mov_b64 exec, -1
L_ci_6:
    s_cmp_eq_u32 s3, 6
    s_cbranch_scc0 L_ones_7
    v_mov_b32 v8, 0x3f803f80
    v_lshlrev_b32 v6, 2, v2
    ds_write_b32 v6, v8 offset:10752
    ds_write_b32 v6, v8 offset:11008
    ds_write_b32 v6, v8 offset:11264
    ds_write_b32 v6, v8 offset:11520
    s_mov_b32 exec_lo, -1
    s_mov_b32 exec_hi, 0
    ds_write_b32 v6, v8 offset:11776
    s_mov_b64 exec, -1
L_ones_7:
    s_cmp_lt_u32 s3, 4
    s_cbranch_scc0 L_ln1_8
    s_cmp_eq_u32 s3, 0
    s_cbranch_scc1 L_w0_9
    s_waitcnt vmcnt(10)
    s_branch L_w1_10
L_w0_9:
    s_waitcnt vmcnt(3)
L_w1_10:
    v_cmp_gt_u32 vcc, 32, v2
    s_nop 1
    v_cndmask_b32 v220, 0, v220, vcc
    v_lshlrev_b32 v224, 16, v216
    v_and_b32 v225, 0xffff0000, v216
    v_lshlrev_b32 v226, 16, v217
    v_and_b32 v227, 0xffff0000, v217
    v_lshlrev_b32 v228, 16, v218
    v_and_b32 v229, 0xffff0000, v218
    v_lshlrev_b32 v230, 16, v219
    v_and_b32 v231, 0xffff0000, v219
    v_lshlrev_b32 v232, 16, v220
    v_and_b32 v233, 0xffff0000, v220
    v_add_f32 v234, v224, v225
    v_add_f32 v234, v234, v226
    v_add_f32 v234, v234, v227
    v_add_f32 v234, v234, v228
    v_add_f32 v234, v234, v229
    v_add_f32 v234, v234, v230
    v_add_f32 v234, v234, v231
    v_add_f32 v234, v234, v232
    v_add_f32 v234, v234, v233
    s_nop 1
    v_add_f32_dpp v234, v234, v234 quad_perm:[1,0,3,2] row_mask:0xf bank_mask:0xf
    s_nop 1
    v_add_f32_dpp v234, v234, v234 quad_perm:[2,3,0,1] row_mask:0xf bank_mask:0xf
    s_nop 1
    v_add_f32_dpp v234, v234, v234 row_half_mirror row_mask:0xf bank_mask:0xf
    s_nop 1
    v_add_f32_dpp v234, v234, v234 row_mirror row_mask:0xf bank_mask:0xf
    v_mov_b32 v24, v234
    s_nop 1
    v_permlane16_swap_b32 v234, v24
    v_add_f32 v234, v234, v24
    v_mov_b32 v24, v234
    s_nop 1
    v_permlane32_swap_b32 v234, v24
    v_add_f32 v234, v234, v24
    v_mul_f32 v234, 0x3ae38e39, v234
    v_sub_f32 v236, v224, v234
    v_sub_f32 v237, v225, v234
    v_sub_f32 v238, v226, v234
    v_sub_f32 v239, v227, v234
    v_sub_f32 v240, v228, v234
    v_sub_f32 v241, v229, v234
    v_sub_f32 v242, v230, v234
    v_sub_f32 v243, v231, v234
    v_sub_f32 v244, v232, v234
    v_sub_f32 v245, v233, v234
    v_cndmask_b32 v244, 0, v244, vcc
    v_cndmask_b32 v245, 0, v245, vcc
    v_mul_f32 v235, v236, v236
    v_fmac_f32 v235, v237, v237
    v_fmac_f32 v235, v238, v238
    v_fmac_f32 v235, v239, v239
    v_fmac_f32 v235, v240, v240
    v_fmac_f32 v235, v241, v241
    v_fmac_f32 v235, v242, v242
    v_fmac_f32 v235, v243, v243
    v_fmac_f32 v235, v244, v244
    v_fmac_f32 v235, v245, v245
    s_nop 1
    v_add_f32_dpp v235, v235, v235 quad_perm:[1,0,3,2] row_mask:0xf bank_mask:0xf
    s_nop 1
    v_add_f32_dpp v235, v235, v235 quad_perm:[2,3,0,1] row_mask:0xf bank_mask:0xf
    s_nop 1
    v_add_f32_dpp v235, v235, v235 row_half_mirror row_mask:0xf bank_mask:0xf
    s_nop 1
    v_add_f32_dpp v235, v235, v235 row_mirror row_mask:0xf bank_mask:0xf
    v_mov_b32 v24, v235
    s_nop 1
    v_permlane16_swap_b32 v235, v24
    v_add_f32 v235, v235, v24
    v_mov_b32 v24, v235
    s_nop 1
    v_permlane32_swap_b32 v235, v24
    v_add_f32 v235, v235, v24
    v_mul_f32 v235, 0x3ae38e39, v235
    v_cvt_pk_bf16_f32 v235, v235, v235
    v_and_b32 v235, 0xffff0000, v235
    v_add_f32 v235, 0x3727c5ac, v235
    v_cvt_pk_bf16_f32 v235, v235, v235
    v_and_b32 v235, 0xffff0000, v235
    v_sqrt_f32 v235, v235
    s_nop 0
    v_cvt_pk_bf16_f32 v235, v235, v235
    v_and_b32 v235, 0xffff0000, v235
    v_rcp_f32 v235, v235
    v_cvt_pk_bf16_f32 v234, v234, v234
    v_and_b32 v234, 0xffff0000, v234
    v_sub_f32 v224, v224, v234
    v_sub_f32 v225, v225, v234
    v_sub_f32 v226, v226, v234
    v_sub_f32 v227, v227, v234
    v_sub_f32 v228, v228, v234
    v_sub_f32 v229, v229, v234
    v_sub_f32 v230, v230, v234
    v_sub_f32 v231, v231, v234
    v_sub_f32 v232, v232, v234
    v_sub_f32 v233, v233, v234
    v_cvt_pk_bf16_f32 v224, v224, v224
    v_and_b32 v224, 0xffff0000, v224
    v_cvt_pk_bf16_f32 v225, v225, v225
    v_and_b32 v225, 0xffff0000, v225
    v_cvt_pk_bf16_f32 v226, v226, v226
    v_and_b32 v226, 0xffff0000, v226
    v_cvt_pk_bf16_f32 v227, v227, v227
    v_and_b32 v227, 0xffff0000, v227
    v_cvt_pk_bf16_f32 v228, v228, v228
    v_and_b32 v228, 0xffff0000, v228
    v_cvt_pk_bf16_f32 v229, v229, v229
    v_and_b32 v229, 0xffff0000, v229
    v_cvt_pk_bf16_f32 v230, v230, v230
    v_and_b32 v230, 0xffff0000, v230
    v_cvt_pk_bf16_f32 v231, v231, v231
    v_and_b32 v231, 0xffff0000, v231
    v_cvt_pk_bf16_f32 v232, v232, v232
    v_and_b32 v232, 0xffff0000, v232
    v_cvt_pk_bf16_f32 v233, v233, v233
    v_and_b32 v233, 0xffff0000, v233
    v_mul_f32 v224, v224, v235
    v_mul_f32 v225, v225, v235
    v_mul_f32 v226, v226, v235
    v_mul_f32 v227, v227, v235
    v_mul_f32 v228, v228, v235
    v_mul_f32 v229, v229, v235
    v_mul_f32 v230, v230, v235
    v_mul_f32 v231, v231, v235
    v_mul_f32 v232, v232, v235
    v_mul_f32 v233, v233, v235
    v_cvt_pk_bf16_f32 v216, v224, v225
    v_cvt_pk_bf16_f32 v217, v226, v227
    v_cvt_pk_bf16_f32 v218, v228, v229
    v_cvt_pk_bf16_f32 v219, v230, v231
    v_cvt_pk_bf16_f32 v220, v232, v233
    s_mul_i32 s88, s3, 1312
    v_lshlrev_b32 v6, 2, v2
    v_add_u32 v6, s88, v6
    ds_write_b32 v6, v216 offset:5504
    ds_write_b32 v6, v217 offset:5760
    ds_write_b32 v6, v218 offset:6016
    ds_write_b32 v6, v219 offset:6272
    s_mov_b32 exec_lo, -1
    s_mov_b32 exec_hi, 0
    ds_write_b32 v6, v220 offset:6528
    s_mov_b64 exec, -1
L_ln1_8:
    s_cmp_eq_u32 s3, 0
    s_cbranch_scc1 L_w0_11
    s_waitcnt vmcnt(8) lgkmcnt(0)
    s_branch L_w1_12
L_w0_11:
    s_waitcnt vmcnt(0) lgkmcnt(0)
L_w1_12:
    s_barrier
    v_readfirstlane_b32 s63, v221
    v_and_b32 v5, 3, v2
    v_mul_u32_u24 v5, 1312, v5
    v_lshl_add_u32 v5, v4, 4, v5
    s_lshl_b32 s88, s3, 6
    v_add_u32 v5, s88, v5
    v_lshrrev_b32 v6, 2, v3
    v_lshl_add_u32 v6, v4, 3, v6
    v_lshlrev_b32 v6, 5, v6
    v_and_b32 v7, 3, v3
    v_lshl_add_u32 v6, v7, 3, v6
    s_lshl_b32 s88, s3, 10
    v_add_u32 v6, s88, v6
    ds_read_b128 v[216:219], v5 offset:5504
    ds_read_b64_tr_b16 v[228:229], v6 offset:19968
    ds_read_b64_tr_b16 v[230:231], v6 offset:20096
    ds_read_b128 v[220:223], v5 offset:6016
    ds_read_b64_tr_b16 v[232:233], v6 offset:28160
    ds_read_b64_tr_b16 v[234:235], v6 offset:28288
    ds_read_b128 v[224:227], v5 offset:6528
    ds_read_b64_tr_b16 v[236:237], v6 offset:36352
    ds_read_b64_tr_b16 v[238:239], v6 offset:36480
    s_waitcnt lgkmcnt(0)
    v_mfma_f32_16x16x32_bf16 v[240:243], v[216:219], v[228:231], 0
    v_mfma_f32_16x16x32_bf16 v[240:243], v[220:223], v[232:235], v[240:243]
    s_cmp_lt_u32 s3, 2
    s_cbranch_scc0 L_q3_13
    v_mfma_f32_16x16x32_bf16 v[240:243], v[224:227], v[236:239], v[240:243]
L_q3_13:
    s_lshl_b32 s88, s3, 8
    v_lshlrev_b32 v5, 2, v2
    v_add_u32 v5, s88, v5
    s_mov_b64 exec, 0xffff
    s_nop 3
    ds_write_b32 v5, v240 offset:17440
    ds_write_b32 v5, v241 offset:17504
    ds_write_b32 v5, v242 offset:17568
    ds_write_b32 v5, v243 offset:17632
    s_mov_b64 exec, -1
    s_waitcnt lgkmcnt(0)
    s_barrier
    v_lshrrev_b32 v134, 2, v2
    v_mul_u32_u24 v134, 9216, v134
    v_and_b32 v7, 3, v2
    v_lshl_add_u32 v134, v7, 4, v134
    s_lshl_b32 s88, s53, 6
    v_add_u32 v134, s88, v134
    v_lshlrev_b32 v135, 4, v2
    s_cmp_eq_u32 s3, 0
    s_cbranch_scc1 L_nofill_14
    v_mov_b32 v216, -1
    v_mov_b32 v217, -1
    v_mov_b32 v218, -1
    v_mov_b32 v219, -1
    v_lshlrev_b32 v5, 4, v0
    s_lshl_b32 s88, s51, 3
    s_lshl_b32 s89, s50, 1
    s_add_u32 s88, s88, s89
    s_add_u32 s88, s88, s52
    s_lshl_b32 s88, s88, 10
    s_add_u32 s88, s88, 0x0
    v_cmp_gt_u32 vcc, 33, v0
    s_and_saveexec_b64 s[90:91], vcc
    s_cbranch_execz L_s1_15
    buffer_store_dwordx4 v[216:219], v5, s[20:23], s88 offen sc1
L_s1_15:
    s_mov_b64 exec, s[90:91]
    s_lshl_b32 s88, s49, 5
    s_add_u32 s88, s88, s48
    s_mul_i32 s88, s88, 1152
    s_add_u32 s88, s88, 0x40000
    v_cmp_gt_u32 vcc, 72, v0
    s_and_saveexec_b64 s[90:91], vcc
    s_cbranch_execz L_s2_16
    buffer_store_dwordx4 v[216:219], v5, s[20:23], s88 offen sc1
L_s2_16:
    s_mov_b64 exec, s[90:91]
    s_cmp_eq_u32 s3, 7
    s_cbranch_scc0 L_s4_17
    s_lshl_b32 s88, s54, 7
    s_lshl_b32 s89, s52, 3
    s_add_u32 s88, s88, s89
    s_add_u32 s88, s88, 0x1f0000
    s_mov_b64 exec, 1
    buffer_store_dwordx2 v[216:217], v141, s[20:23], s88 offen sc1
    s_mov_b64 exec, -1
L_s4_17:
    s_cmp_lt_u32 s53, 144
    s_cbranch_scc0 L_s3_18
    s_mul_i32 s88, s53, 9216
    s_add_u32 s88, s88, 0x90000
    buffer_store_dwordx4 v[216:219], v5, s[20:23], s88 offen sc1
    s_and_b32 s90, s2, 7
    s_lshr_b32 s91, s2, 3
    s_mul_i32 s90, s90, 72
    s_lshl_b32 s91, s91, 2
    s_add_u32 s90, s90, s91
    v_and_b32 v6, 3, v2
    v_add_u32 v6, s90, v6
    v_lshlrev_b32 v6, 1, v6
    buffer_load_ushort v136, v6, s[4:7], 0 offen offset:0
    buffer_load_ushort v137, v6, s[4:7], 0 offen offset:1152
    buffer_load_ushort v138, v6, s[4:7], 0 offen offset:2304
    buffer_load_ushort v139, v6, s[4:7], 0 offen offset:3456
    s_cmp_eq_u32 s3, 0
    s_cbranch_scc0 L_s3_18
    s_add_u32 s88, s88, 8192
    buffer_store_dwordx4 v[216:219], v5, s[20:23], s88 offen sc1
    s_lshl_b32 s88, s90, 4
    s_add_u32 s88, s88, 0x200000
    v_lshrrev_b32 v6, 2, v2
    v_mul_u32_u24 v6, 9216, v6
    v_and_b32 v7, 3, v2
    v_lshl_add_u32 v6, v7, 4, v6
    buffer_store_dwordx4 v[216:219], v6, s[20:23], s88 offen sc1
    buffer_load_dword v142, v141, s[40:43], 0 offen
L_s3_18:
    s_sub_u32 s55, s3, 1
    s_lshr_b32 s88, s55, 3
    s_lshl_b32 s88, s88, 4
    s_and_b32 s89, s55, 7
    s_add_u32 s88, s88, s89
    s_lshl_b32 s89, s52, 3
    s_add_u32 s88, s88, s89
    s_lshl_b32 s56, s88, 12
    buffer_load_dwordx4 v[80:83], v128, s[8:11], s56 offen offset:0 nt
    buffer_load_dwordx4 v[84:87], v128, s[8:11], s56 offen offset:64 nt
    buffer_load_dwordx4 v[88:91], v128, s[8:11], s56 offen offset:128 nt
    buffer_load_dwordx4 v[92:95], v128, s[8:11], s56 offen offset:192 nt
    buffer_load_dwordx4 v[96:99], v129, s[12:15], s56 offen offset:0 nt
    buffer_load_dwordx4 v[100:103], v129, s[12:15], s56 offen offset:256 nt
    buffer_load_dwordx4 v[104:107], v129, s[12:15], s56 offen offset:512 nt
    buffer_load_dwordx4 v[108:111], v129, s[12:15], s56 offen offset:768 nt
L_nofill_14:
    s_cmp_eq_u32 s3, 0
    s_cbranch_scc0 L_qdone_19
    s_mul_i32 s60, s63, 0x9E3779B1
    s_add_u32 s60, s60, 0x85EBCA6B
    v_lshlrev_b32 v5, 3, v2
    ds_read_b64 v[216:217], v5 offset:17440
    ds_read_b64 v[218:219], v5 offset:17696
    ds_read_b64 v[220:221], v5 offset:17952
    ds_read_b64 v[222:223], v5 offset:18208
    ds_read_b64 v[224:225], v5 offset:18464
    ds_read_b64 v[226:227], v5 offset:18720
    ds_read_b64 v[228:229], v5 offset:18976
    ds_read_b64 v[230:231], v5 offset:19232
    s_waitcnt lgkmcnt(0)
    v_add_f32 v216, v216, v218
    v_add_f32 v217, v217, v219
    v_add_f32 v216, v216, v220
    v_add_f32 v217, v217, v221
    v_add_f32 v216, v216, v222
    v_add_f32 v217, v217, v223
    v_add_f32 v216, v216, v224
    v_add_f32 v217, v217, v225
    v_add_f32 v216, v216, v226
    v_add_f32 v217, v217, v227
    v_add_f32 v216, v216, v228
    v_add_f32 v217, v217, v229
    v_add_f32 v216, v216, v230
    v_add_f32 v217, v217, v231
    v_cvt_pk_bf16_f32 v216, v216, v217
    v_mov_b32 v217, s60
    v_lshrrev_b32 v5, 3, v2
    v_lshlrev_b32 v5, 9, v5
    v_and_b32 v6, 7, v2
    v_lshl_add_u32 v5, v6, 3, v5
    s_lshl_b32 s88, s48, 11
    s_lshl_b32 s89, s49, 6
    s_add_u32 s88, s88, s89
    s_add_u32 s88, s88, 0x1e0000
    s_mov_b32 exec_lo, -1
    s_mov_b32 exec_hi, 0
    buffer_store_dwordx2 v[216:217], v5, s[20:23], s88 offen sc1
    s_mov_b64 exec, -1
    s_lshl_b32 s88, s51, 2
    s_add_u32 s88, s88, s50
    s_lshl_b32 s88, s88, 9
    s_add_u32 s88, s88, 0x1e0000
    v_lshlrev_b32 v5, 3, v2
    s_mov_b32 s96, 0
L_pq_20:
    buffer_load_dwordx2 v[218:219], v5, s[20:23], s88 offen sc1
    s_waitcnt vmcnt(0)
    v_cmp_ne_u32 vcc, s60, v219
    s_cbranch_vccz L_pqd_21
    s_add_u32 s96, s96, 1
    s_cmp_lt_u32 s96, 0x40000
    s_cbranch_scc1 L_pq_20
L_pqd_21:
    v_lshlrev_b32 v5, 2, v2
    ds_write_b32 v5, v218 offset:19488
    v_mov_b32 v216, -1
    v_mov_b32 v217, -1
    v_mov_b32 v218, -1
    v_mov_b32 v219, -1
    v_lshlrev_b32 v5, 4, v0
    s_lshl_b32 s88, s51, 3
    s_lshl_b32 s89, s50, 1
    s_add_u32 s88, s88, s89
    s_add_u32 s88, s88, s52
    s_lshl_b32 s88, s88, 10
    s_add_u32 s88, s88, 0x0
    v_cmp_gt_u32 vcc, 33, v0
    s_and_saveexec_b64 s[90:91], vcc
    s_cbranch_execz L_s1_22
    buffer_store_dwordx4 v[216:219], v5, s[20:23], s88 offen sc1
L_s1_22:
    s_mov_b64 exec, s[90:91]
    s_lshl_b32 s88, s49, 5
    s_add_u32 s88, s88, s48
    s_mul_i32 s88, s88, 1152
    s_add_u32 s88, s88, 0x40000
    v_cmp_gt_u32 vcc, 72, v0
    s_and_saveexec_b64 s[90:91], vcc
    s_cbranch_execz L_s2_23
    buffer_store_dwordx4 v[216:219], v5, s[20:23], s88 offen sc1
L_s2_23:
    s_mov_b64 exec, s[90:91]
    s_cmp_eq_u32 s3, 7
    s_cbranch_scc0 L_s4_24
    s_lshl_b32 s88, s54, 7
    s_lshl_b32 s89, s52, 3
    s_add_u32 s88, s88, s89
    s_add_u32 s88, s88, 0x1f0000
    s_mov_b64 exec, 1
    buffer_store_dwordx2 v[216:217], v141, s[20:23], s88 offen sc1
    s_mov_b64 exec, -1
L_s4_24:
    s_cmp_lt_u32 s53, 144
    s_cbranch_scc0 L_s3_25
    s_mul_i32 s88, s53, 9216
    s_add_u32 s88, s88, 0x90000
    buffer_store_dwordx4 v[216:219], v5, s[20:23], s88 offen sc1
    s_and_b32 s90, s2, 7
    s_lshr_b32 s91, s2, 3
    s_mul_i32 s90, s90, 72
    s_lshl_b32 s91, s91, 2
    s_add_u32 s90, s90, s91
    v_and_b32 v6, 3, v2
    v_add_u32 v6, s90, v6
    v_lshlrev_b32 v6, 1, v6
    buffer_load_ushort v136, v6, s[4:7], 0 offen offset:0
    buffer_load_ushort v137, v6, s[4:7], 0 offen offset:1152
    buffer_load_ushort v138, v6, s[4:7], 0 offen offset:2304
    buffer_load_ushort v139, v6, s[4:7], 0 offen offset:3456
    s_cmp_eq_u32 s3, 0
    s_cbranch_scc0 L_s3_25
    s_add_u32 s88, s88, 8192
    buffer_store_dwordx4 v[216:219], v5, s[20:23], s88 offen sc1
    s_lshl_b32 s88, s90, 4
    s_add_u32 s88, s88, 0x200000
    v_lshrrev_b32 v6, 2, v2
    v_mul_u32_u24 v6, 9216, v6
    v_and_b32 v7, 3, v2
    v_lshl_add_u32 v6, v7, 4, v6
    buffer_store_dwordx4 v[216:219], v6, s[20:23], s88 offen sc1
    buffer_load_dword v142, v141, s[40:43], 0 offen
L_s3_25:
    s_mov_b32 s55, 7
    s_lshr_b32 s88, s55, 3
    s_lshl_b32 s88, s88, 4
    s_and_b32 s89, s55, 7
    s_add_u32 s88, s88, s89
    s_lshl_b32 s89, s52, 3
    s_add_u32 s88, s88, s89
    s_lshl_b32 s56, s88, 12
    buffer_load_dwordx4 v[48:51], v128, s[8:11], s56 offen offset:0 nt
    buffer_load_dwordx4 v[52:55], v128, s[8:11], s56 offen offset:64 nt
    buffer_load_dwordx4 v[56:59], v128, s[8:11], s56 offen offset:128 nt
    buffer_load_dwordx4 v[60:63], v128, s[8:11], s56 offen offset:192 nt
    buffer_load_dwordx4 v[64:67], v129, s[12:15], s56 offen offset:0 nt
    buffer_load_dwordx4 v[68:71], v129, s[12:15], s56 offen offset:256 nt
    buffer_load_dwordx4 v[72:75], v129, s[12:15], s56 offen offset:512 nt
    buffer_load_dwordx4 v[76:79], v129, s[12:15], s56 offen offset:768 nt
    s_waitcnt lgkmcnt(0)
L_qdone_19:
    s_barrier
    v_lshlrev_b32 v5, 4, v4
    ds_read_b128 v[32:35], v5 offset:19488
    ds_read_b128 v[36:39], v5 offset:19552
    ds_read_b128 v[40:43], v5 offset:19616
    ds_read_b128 v[44:47], v5 offset:19680
    s_mov_b32 s57, 0x3db504f3
    s_mov_b32 s58, 0x3fb8aa3b
    v_mov_b32 v120, 0xff800000
    v_mov_b32 v121, 0
    v_mov_b32 v116, 0
    v_mov_b32 v117, 0
    v_mov_b32 v118, 0
    v_mov_b32 v119, 0
    s_waitcnt lgkmcnt(0)
    s_cmp_eq_u32 s3, 0
    s_cbranch_scc1 L_m0_26
    s_mov_b64 exec, 1
    ds_add_rtn_u32 v127, v133, v132 offset:0
    s_mov_b64 exec, -1
    s_waitcnt vmcnt(12)
    v_mfma_f32_16x16x32_bf16 v[112:115], v[48:51], v[32:35], 0
    v_mfma_f32_16x16x32_bf16 v[112:115], v[52:55], v[36:39], v[112:115]
    v_mfma_f32_16x16x32_bf16 v[112:115], v[56:59], v[40:43], v[112:115]
    v_mfma_f32_16x16x32_bf16 v[112:115], v[60:63], v[44:47], v[112:115]
    s_waitcnt lgkmcnt(0)
    v_readfirstlane_b32 s55, v127
    s_lshr_b32 s88, s55, 3
    s_lshl_b32 s88, s88, 4
    s_and_b32 s89, s55, 7
    s_add_u32 s88, s88, s89
    s_lshl_b32 s89, s52, 3
    s_add_u32 s88, s88, s89
    s_lshl_b32 s56, s88, 12
    buffer_load_dwordx4 v[48:51], v128, s[8:11], s56 offen offset:0 nt
    buffer_load_dwordx4 v[52:55], v128, s[8:11], s56 offen offset:64 nt
    buffer_load_dwordx4 v[56:59], v128, s[8:11], s56 offen offset:128 nt
    buffer_load_dwordx4 v[60:63], v128, s[8:11], s56 offen offset:192 nt
    v_cvt_pk_bf16_f32 v24, v112, v113
    v_cvt_pk_bf16_f32 v25, v114, v115
    v_lshlrev_b32 v112, 16, v24
    v_and_b32 v113, 0xffff0000, v24
    v_lshlrev_b32 v114, 16, v25
    v_and_b32 v115, 0xffff0000, v25
    v_mul_f32 v112, s57, v112
    v_mul_f32 v113, s57, v113
    v_mul_f32 v114, s57, v114
    v_mul_f32 v115, s57, v115
    v_cvt_pk_bf16_f32 v24, v112, v113
    v_cvt_pk_bf16_f32 v25, v114, v115
    v_lshlrev_b32 v112, 16, v24
    v_and_b32 v113, 0xffff0000, v24
    v_lshlrev_b32 v114, 16, v25
    v_and_b32 v115, 0xffff0000, v25
    v_max_f32 v24, v112, v113
    v_max3_f32 v24, v24, v114, v115
    v_mov_b32 v25, v24
    s_nop 1
    v_permlane16_swap_b32 v24, v25
    v_max_f32 v24, v24, v25
    v_mov_b32 v25, v24
    s_nop 1
    v_permlane32_swap_b32 v24, v25
    v_max_f32 v24, v24, v25
    v_mul_f32 v24, s58, v24
    v_max_f32 v24, v120, v24
    v_sub_f32 v122, v120, v24
    v_exp_f32 v122, v122
    v_mov_b32 v120, v24
    v_fma_f32 v123, v112, s58, -v120
    v_fma_f32 v124, v113, s58, -v120
    v_fma_f32 v125, v114, s58, -v120
    v_fma_f32 v126, v115, s58, -v120
    v_exp_f32 v123, v123
    v_exp_f32 v124, v124
    v_exp_f32 v125, v125
    v_exp_f32 v126, v126
    v_mul_f32 v121, v121, v122
    v_mul_f32 v116, v116, v122
    v_mul_f32 v117, v117, v122
    v_mul_f32 v118, v118, v122
    v_mul_f32 v119, v119, v122
    v_add_f32 v121, v121, v123
    v_add_f32 v121, v121, v124
    v_add_f32 v121, v121, v125
    v_add_f32 v121, v121, v126
    v_cvt_pk_bf16_f32 v24, v123, v123
    v_and_b32 v8, v24, v28
    v_and_b32 v9, v24, v29
    v_and_b32 v10, v24, v30
    v_and_b32 v11, v24, v31
    v_cvt_pk_bf16_f32 v24, v124, v124
    v_and_b32 v12, v24, v28
    v_and_b32 v13, v24, v29
    v_and_b32 v14, v24, v30
    v_and_b32 v15, v24, v31
    v_cvt_pk_bf16_f32 v24, v125, v125
    v_and_b32 v16, v24, v28
    v_and_b32 v17, v24, v29
    v_and_b32 v18, v24, v30
    v_and_b32 v19, v24, v31
    v_cvt_pk_bf16_f32 v24, v126, v126
    v_and_b32 v20, v24, v28
    v_and_b32 v21, v24, v29
    v_and_b32 v22, v24, v30
    v_and_b32 v23, v24, v31
    s_waitcnt vmcnt(12)
    v_mfma_f32_16x16x32_bf16 v[116:119], v[64:67], v[8:11], v[116:119]
    v_mfma_f32_16x16x32_bf16 v[116:119], v[68:71], v[12:15], v[116:119]
    v_mfma_f32_16x16x32_bf16 v[116:119], v[72:75], v[16:19], v[116:119]
    v_mfma_f32_16x16x32_bf16 v[116:119], v[76:79], v[20:23], v[116:119]
    buffer_load_dwordx4 v[64:67], v129, s[12:15], s56 offen offset:0 nt
    buffer_load_dwordx4 v[68:71], v129, s[12:15], s56 offen offset:256 nt
    buffer_load_dwordx4 v[72:75], v129, s[12:15], s56 offen offset:512 nt
    buffer_load_dwordx4 v[76:79], v129, s[12:15], s56 offen offset:768 nt
    s_waitcnt vmcnt(12)
    v_mfma_f32_16x16x32_bf16 v[112:115], v[80:83], v[32:35], 0
    v_mfma_f32_16x16x32_bf16 v[112:115], v[84:87], v[36:39], v[112:115]
    v_mfma_f32_16x16x32_bf16 v[112:115], v[88:91], v[40:43], v[112:115]
    v_mfma_f32_16x16x32_bf16 v[112:115], v[92:95], v[44:47], v[112:115]
    s_nop 7
    v_cvt_pk_bf16_f32 v24, v112, v113
    v_cvt_pk_bf16_f32 v25, v114, v115
    v_lshlrev_b32 v112, 16, v24
    v_and_b32 v113, 0xffff0000, v24
    v_lshlrev_b32 v114, 16, v25
    v_and_b32 v115, 0xffff0000, v25
    v_mul_f32 v112, s57, v112
    v_mul_f32 v113, s57, v113
    v_mul_f32 v114, s57, v114
    v_mul_f32 v115, s57, v115
    v_cvt_pk_bf16_f32 v24, v112, v113
    v_cvt_pk_bf16_f32 v25, v114, v115
    v_lshlrev_b32 v112, 16, v24
    v_and_b32 v113, 0xffff0000, v24
    v_lshlrev_b32 v114, 16, v25
    v_and_b32 v115, 0xffff0000, v25
    v_max_f32 v24, v112, v113
    v_max3_f32 v24, v24, v114, v115
    v_mov_b32 v25, v24
    s_nop 1
    v_permlane16_swap_b32 v24, v25
    v_max_f32 v24, v24, v25
    v_mov_b32 v25, v24
    s_nop 1
    v_permlane32_swap_b32 v24, v25
    v_max_f32 v24, v24, v25
    v_mul_f32 v24, s58, v24
    v_max_f32 v24, v120, v24
    v_sub_f32 v122, v120, v24
    v_exp_f32 v122, v122
    v_mov_b32 v120, v24
    v_fma_f32 v123, v112, s58, -v120
    v_fma_f32 v124, v113, s58, -v120
    v_fma_f32 v125, v114, s58, -v120
    v_fma_f32 v126, v115, s58, -v120
    v_exp_f32 v123, v123
    v_exp_f32 v124, v124
    v_exp_f32 v125, v125
    v_exp_f32 v126, v126
    v_mul_f32 v121, v121, v122
    v_mul_f32 v116, v116, v122
    v_mul_f32 v117, v117, v122
    v_mul_f32 v118, v118, v122
    v_mul_f32 v119, v119, v122
    v_add_f32 v121, v121, v123
    v_add_f32 v121, v121, v124
    v_add_f32 v121, v121, v125
    v_add_f32 v121, v121, v126
    v_cvt_pk_bf16_f32 v24, v123, v123
    v_and_b32 v8, v24, v28
    v_and_b32 v9, v24, v29
    v_and_b32 v10, v24, v30
    v_and_b32 v11, v24, v31
    v_cvt_pk_bf16_f32 v24, v124, v124
    v_and_b32 v12, v24, v28
    v_and_b32 v13, v24, v29
    v_and_b32 v14, v24, v30
    v_and_b32 v15, v24, v31
    v_cvt_pk_bf16_f32 v24, v125, v125
    v_and_b32 v16, v24, v28
    v_and_b32 v17, v24, v29
    v_and_b32 v18, v24, v30
    v_and_b32 v19, v24, v31
    v_cvt_pk_bf16_f32 v24, v126, v126
    v_and_b32 v20, v24, v28
    v_and_b32 v21, v24, v29
    v_and_b32 v22, v24, v30
    v_and_b32 v23, v24, v31
    s_waitcnt vmcnt(8)
    v_mfma_f32_16x16x32_bf16 v[116:119], v[96:99], v[8:11], v[116:119]
    v_mfma_f32_16x16x32_bf16 v[116:119], v[100:103], v[12:15], v[116:119]
    v_mfma_f32_16x16x32_bf16 v[116:119], v[104:107], v[16:19], v[116:119]
    v_mfma_f32_16x16x32_bf16 v[116:119], v[108:111], v[20:23], v[116:119]
    s_branch L_m1_27
L_m0_26:
    s_mov_b64 exec, 1
    ds_add_rtn_u32 v127, v133, v132 offset:0
    s_mov_b64 exec, -1
    s_waitcnt vmcnt(4)
    v_mfma_f32_16x16x32_bf16 v[112:115], v[48:51], v[32:35], 0
    v_mfma_f32_16x16x32_bf16 v[112:115], v[52:55], v[36:39], v[112:115]
    v_mfma_f32_16x16x32_bf16 v[112:115], v[56:59], v[40:43], v[112:115]
    v_mfma_f32_16x16x32_bf16 v[112:115], v[60:63], v[44:47], v[112:115]
    s_waitcnt lgkmcnt(0)
    v_readfirstlane_b32 s55, v127
    s_cmp_lt_u32 s55, 216
    s_cbranch_scc0 L_late_28
    s_lshr_b32 s88, s55, 3
    s_lshl_b32 s88, s88, 4
    s_and_b32 s89, s55, 7
    s_add_u32 s88, s88, s89
    s_lshl_b32 s89, s52, 3
    s_add_u32 s88, s88, s89
    s_lshl_b32 s56, s88, 12
    s_branch L_join_29
L_late_28:
    s_cmp_lt_u32 s97, 65536
    s_cbranch_scc1 L_known_30
    s_mov_b32 s96, 0
L_wf_31:
    ds_read_b32 v5, v133 offset:32
    s_waitcnt lgkmcnt(0)
    v_readfirstlane_b32 s88, v5
    s_cmp_lg_u32 s88, 0
    s_cbranch_scc1 L_wfd_32
    s_sleep 2
    s_add_u32 s96, s96, 1
    s_cmp_lt_u32 s96, 0x100000
    s_cbranch_scc1 L_wf_31
L_wfd_32:
    s_mov_b32 s97, s88
    ds_read_b32 v5, v133 offset:36
    s_waitcnt lgkmcnt(0)
    v_readfirstlane_b32 s100, v5
L_known_30:
    s_sub_u32 s90, s55, s100
    s_xor_b32 s91, s52, 1
    s_cmp_ge_u32 s55, 256
    s_cselect_b32 s90, s90, s55
    s_cselect_b32 s91, s91, s52
    s_lshr_b32 s88, s90, 3
    s_lshl_b32 s88, s88, 4
    s_and_b32 s89, s90, 7
    s_add_u32 s88, s88, s89
    s_lshl_b32 s89, s91, 3
    s_add_u32 s88, s88, s89
    s_cmp_lt_u32 s55, s97
    s_cselect_b32 s88, s88, 0x200
    s_lshl_b32 s56, s88, 12
L_join_29:
    buffer_load_dwordx4 v[48:51], v128, s[8:11], s56 offen offset:0 nt
    buffer_load_dwordx4 v[52:55], v128, s[8:11], s56 offen offset:64 nt
    buffer_load_dwordx4 v[56:59], v128, s[8:11], s56 offen offset:128 nt
    buffer_load_dwordx4 v[60:63], v128, s[8:11], s56 offen offset:192 nt
    v_cvt_pk_bf16_f32 v24, v112, v113
    v_cvt_pk_bf16_f32 v25, v114, v115
    v_lshlrev_b32 v112, 16, v24
    v_and_b32 v113, 0xffff0000, v24
    v_lshlrev_b32 v114, 16, v25
    v_and_b32 v115, 0xffff0000, v25
    v_mul_f32 v112, s57, v112
    v_mul_f32 v113, s57, v113
    v_mul_f32 v114, s57, v114
    v_mul_f32 v115, s57, v115
    v_cvt_pk_bf16_f32 v24, v112, v113
    v_cvt_pk_bf16_f32 v25, v114, v115
    v_lshlrev_b32 v112, 16, v24
    v_and_b32 v113, 0xffff0000, v24
    v_lshlrev_b32 v114, 16, v25
    v_and_b32 v115, 0xffff0000, v25
    v_max_f32 v24, v112, v113
    v_max3_f32 v24, v24, v114, v115
    v_mov_b32 v25, v24
    s_nop 1
    v_permlane16_swap_b32 v24, v25
    v_max_f32 v24, v24, v25
    v_mov_b32 v25, v24
    s_nop 1
    v_permlane32_swap_b32 v24, v25
    v_max_f32 v24, v24, v25
    v_mul_f32 v24, s58, v24
    v_max_f32 v24, v120, v24
    v_sub_f32 v122, v120, v24
    v_exp_f32 v122, v122
    v_mov_b32 v120, v24
    v_fma_f32 v123, v112, s58, -v120
    v_fma_f32 v124, v113, s58, -v120
    v_fma_f32 v125, v114, s58, -v120
    v_fma_f32 v126, v115, s58, -v120
    v_exp_f32 v123, v123
    v_exp_f32 v124, v124
    v_exp_f32 v125, v125
    v_exp_f32 v126, v126
    v_mul_f32 v121, v121, v122
    v_mul_f32 v116, v116, v122
    v_mul_f32 v117, v117, v122
    v_mul_f32 v118, v118, v122
    v_mul_f32 v119, v119, v122
    v_add_f32 v121, v121, v123
    v_add_f32 v121, v121, v124
    v_add_f32 v121, v121, v125
    v_add_f32 v121, v121, v126
    v_cvt_pk_bf16_f32 v24, v123, v123
    v_and_b32 v8, v24, v28
    v_and_b32 v9, v24, v29
    v_and_b32 v10, v24, v30
    v_and_b32 v11, v24, v31
    v_cvt_pk_bf16_f32 v24, v124, v124
    v_and_b32 v12, v24, v28
    v_and_b32 v13, v24, v29
    v_and_b32 v14, v24, v30
    v_and_b32 v15, v24, v31
    v_cvt_pk_bf16_f32 v24, v125, v125
    v_and_b32 v16, v24, v28
    v_and_b32 v17, v24, v29
    v_and_b32 v18, v24, v30
    v_and_b32 v19, v24, v31
    v_cvt_pk_bf16_f32 v24, v126, v126
    v_and_b32 v20, v24, v28
    v_and_b32 v21, v24, v29
    v_and_b32 v22, v24, v30
    v_and_b32 v23, v24, v31
    s_waitcnt vmcnt(4)
    v_mfma_f32_16x16x32_bf16 v[116:119], v[64:67], v[8:11], v[116:119]
    v_mfma_f32_16x16x32_bf16 v[116:119], v[68:71], v[12:15], v[116:119]
    v_mfma_f32_16x16x32_bf16 v[116:119], v[72:75], v[16:19], v[116:119]
    v_mfma_f32_16x16x32_bf16 v[116:119], v[76:79], v[20:23], v[116:119]
    buffer_load_dwordx4 v[64:67], v129, s[12:15], s56 offen offset:0 nt
    buffer_load_dwordx4 v[68:71], v129, s[12:15], s56 offen offset:256 nt
    buffer_load_dwordx4 v[72:75], v129, s[12:15], s56 offen offset:512 nt
    buffer_load_dwordx4 v[76:79], v129, s[12:15], s56 offen offset:768 nt
L_m1_27:
    s_mov_b64 exec, 1
    ds_add_rtn_u32 v5, v133, v132 offset:4
    s_waitcnt lgkmcnt(0)
    v_readfirstlane_b32 s88, v5
    s_cmp_eq_u32 s88, 7
    s_cbranch_scc0 L_arr_33
    v_mov_b32 v6, 1
    buffer_atomic_add v6, v141, s[44:47], 0 offen
L_arr_33:
    s_mov_b64 exec, -1
    s_mul_i32 s62, s76, 18
    s_mov_b32 s61, s3
L_dl_34:
    s_cmp_lt_u32 s61, s62
    s_cbranch_scc0 L_dlx_35
    s_mul_i32 s92, s61, 3641
    s_lshr_b32 s92, s92, 16
    s_mul_i32 s93, s92, 18
    s_sub_u32 s93, s61, s93
    s_sub_u32 s91, s49, 4
    s_cmp_eq_u32 s92, 0
    s_cselect_b32 s91, s49, s91
    s_cmp_eq_u32 s92, 2
    s_cselect_b32 s91, 4, s91
    s_cmp_eq_u32 s92, 3
    s_cselect_b32 s91, 0, s91
    s_lshl_b32 s89, s93, 6
    v_add_u32 v5, s89, v2
    s_mov_b32 s90, 7282
    v_mul_lo_u32 v6, v5, s90
    v_lshrrev_b32 v6, 16, v6
    v_mul_u32_u24 v7, 9, v6
    v_sub_u32 v7, v5, v7
    v_mul_u32_u24 v6, 1152, v6
    v_lshl_add_u32 v6, v7, 4, v6
    s_mul_i32 s90, s48, 147456
    s_mul_i32 s91, s91, 144
    s_add_u32 s90, s90, s91
    s_mul_i32 s89, s92, 18688
    s_lshl_b32 s93, s93, 10
    s_add_u32 s89, s89, s93
    s_add_u32 m0, s89, 19968
    s_nop 0
    buffer_load_dwordx4 v6, s[24:27], s90 offen nt lds
    s_add_u32 s61, s61, 8
    s_branch L_dl_34
L_dlx_35:
    s_mov_b64 exec, 1
    ds_add_rtn_u32 v127, v133, v132 offset:0
    s_mov_b64 exec, -1
    s_waitcnt vmcnt(4)
    v_mfma_f32_16x16x32_bf16 v[112:115], v[48:51], v[32:35], 0
    v_mfma_f32_16x16x32_bf16 v[112:115], v[52:55], v[36:39], v[112:115]
    v_mfma_f32_16x16x32_bf16 v[112:115], v[56:59], v[40:43], v[112:115]
    v_mfma_f32_16x16x32_bf16 v[112:115], v[60:63], v[44:47], v[112:115]
    s_waitcnt lgkmcnt(0)
    v_readfirstlane_b32 s55, v127
    s_cmp_lt_u32 s55, 216
    s_cbranch_scc0 L_late_36
    s_lshr_b32 s88, s55, 3
    s_lshl_b32 s88, s88, 4
    s_and_b32 s89, s55, 7
    s_add_u32 s88, s88, s89
    s_lshl_b32 s89, s52, 3
    s_add_u32 s88, s88, s89
    s_lshl_b32 s56, s88, 12
    s_branch L_join_37
L_late_36:
    s_cmp_lt_u32 s97, 65536
    s_cbranch_scc1 L_known_38
    s_mov_b32 s96, 0
L_wf_39:
    ds_read_b32 v5, v133 offset:32
    s_waitcnt lgkmcnt(0)
    v_readfirstlane_b32 s88, v5
    s_cmp_lg_u32 s88, 0
    s_cbranch_scc1 L_wfd_40
    s_sleep 2
    s_add_u32 s96, s96, 1
    s_cmp_lt_u32 s96, 0x100000
    s_cbranch_scc1 L_wf_39
L_wfd_40:
    s_mov_b32 s97, s88
    ds_read_b32 v5, v133 offset:36
    s_waitcnt lgkmcnt(0)
    v_readfirstlane_b32 s100, v5
L_known_38:
    s_sub_u32 s90, s55, s100
    s_xor_b32 s91, s52, 1
    s_cmp_ge_u32 s55, 256
    s_cselect_b32 s90, s90, s55
    s_cselect_b32 s91, s91, s52
    s_lshr_b32 s88, s90, 3
    s_lshl_b32 s88, s88, 4
    s_and_b32 s89, s90, 7
    s_add_u32 s88, s88, s89
    s_lshl_b32 s89, s91, 3
    s_add_u32 s88, s88, s89
    s_cmp_lt_u32 s55, s97
    s_cselect_b32 s88, s88, 0x200
    s_lshl_b32 s56, s88, 12
L_join_37:
    buffer_load_dwordx4 v[48:51], v128, s[8:11], s56 offen offset:0 nt
    buffer_load_dwordx4 v[52:55], v128, s[8:11], s56 offen offset:64 nt
    buffer_load_dwordx4 v[56:59], v128, s[8:11], s56 offen offset:128 nt
    buffer_load_dwordx4 v[60:63], v128, s[8:11], s56 offen offset:192 nt
    v_cvt_pk_bf16_f32 v24, v112, v113
    v_cvt_pk_bf16_f32 v25, v114, v115
    v_lshlrev_b32 v112, 16, v24
    v_and_b32 v113, 0xffff0000, v24
    v_lshlrev_b32 v114, 16, v25
    v_and_b32 v115, 0xffff0000, v25
    v_mul_f32 v112, s57, v112
    v_mul_f32 v113, s57, v113
    v_mul_f32 v114, s57, v114
    v_mul_f32 v115, s57, v115
    v_cvt_pk_bf16_f32 v24, v112, v113
    v_cvt_pk_bf16_f32 v25, v114, v115
    v_lshlrev_b32 v112, 16, v24
    v_and_b32 v113, 0xffff0000, v24
    v_lshlrev_b32 v114, 16, v25
    v_and_b32 v115, 0xffff0000, v25
    v_max_f32 v24, v112, v113
    v_max3_f32 v24, v24, v114, v115
    v_mov_b32 v25, v24
    s_nop 1
    v_permlane16_swap_b32 v24, v25
    v_max_f32 v24, v24, v25
    v_mov_b32 v25, v24
    s_nop 1
    v_permlane32_swap_b32 v24, v25
    v_max_f32 v24, v24, v25
    v_mul_f32 v24, s58, v24
    v_max_f32 v24, v120, v24
    v_sub_f32 v122, v120, v24
    v_exp_f32 v122, v122
    v_mov_b32 v120, v24
    v_fma_f32 v123, v112, s58, -v120
    v_fma_f32 v124, v113, s58, -v120
    v_fma_f32 v125, v114, s58, -v120
    v_fma_f32 v126, v115, s58, -v120
    v_exp_f32 v123, v123
    v_exp_f32 v124, v124
    v_exp_f32 v125, v125
    v_exp_f32 v126, v126
    v_mul_f32 v121, v121, v122
    v_mul_f32 v116, v116, v122
    v_mul_f32 v117, v117, v122
    v_mul_f32 v118, v118, v122
    v_mul_f32 v119, v119, v122
    v_add_f32 v121, v121, v123
    v_add_f32 v121, v121, v124
    v_add_f32 v121, v121, v125
    v_add_f32 v121, v121, v126
    v_cvt_pk_bf16_f32 v24, v123, v123
    v_and_b32 v8, v24, v28
    v_and_b32 v9, v24, v29
    v_and_b32 v10, v24, v30
    v_and_b32 v11, v24, v31
    v_cvt_pk_bf16_f32 v24, v124, v124
    v_and_b32 v12, v24, v28
    v_and_b32 v13, v24, v29
    v_and_b32 v14, v24, v30
    v_and_b32 v15, v24, v31
    v_cvt_pk_bf16_f32 v24, v125, v125
    v_and_b32 v16, v24, v28
    v_and_b32 v17, v24, v29
    v_and_b32 v18, v24, v30
    v_and_b32 v19, v24, v31
    v_cvt_pk_bf16_f32 v24, v126, v126
    v_and_b32 v20, v24, v28
    v_and_b32 v21, v24, v29
    v_and_b32 v22, v24, v30
    v_and_b32 v23, v24, v31
    s_waitcnt vmcnt(4)
    v_mfma_f32_16x16x32_bf16 v[116:119], v[64:67], v[8:11], v[116:119]
    v_mfma_f32_16x16x32_bf16 v[116:119], v[68:71], v[12:15], v[116:119]
    v_mfma_f32_16x16x32_bf16 v[116:119], v[72:75], v[16:19], v[116:119]
    v_mfma_f32_16x16x32_bf16 v[116:119], v[76:79], v[20:23], v[116:119]
    buffer_load_dwordx4 v[64:67], v129, s[12:15], s56 offen offset:0 nt
    buffer_load_dwordx4 v[68:71], v129, s[12:15], s56 offen offset:256 nt
    buffer_load_dwordx4 v[72:75], v129, s[12:15], s56 offen offset:512 nt
    buffer_load_dwordx4 v[76:79], v129, s[12:15], s56 offen offset:768 nt
    s_cmp_ge_u32 s3, 5
    s_cbranch_scc0 L_go_41
    s_waitcnt vmcnt(4)
    v_mfma_f32_16x16x32_bf16 v[112:115], v[48:51], v[32:35], 0
    v_mfma_f32_16x16x32_bf16 v[112:115], v[52:55], v[36:39], v[112:115]
    v_mfma_f32_16x16x32_bf16 v[112:115], v[56:59], v[40:43], v[112:115]
    v_mfma_f32_16x16x32_bf16 v[112:115], v[60:63], v[44:47], v[112:115]
    s_nop 7
    v_cvt_pk_bf16_f32 v24, v112, v113
    v_cvt_pk_bf16_f32 v25, v114, v115
    v_lshlrev_b32 v112, 16, v24
    v_and_b32 v113, 0xffff0000, v24
    v_lshlrev_b32 v114, 16, v25
    v_and_b32 v115, 0xffff0000, v25
    v_mul_f32 v112, s57, v112
    v_mul_f32 v113, s57, v113
    v_mul_f32 v114, s57, v114
    v_mul_f32 v115, s57, v115
    v_cvt_pk_bf16_f32 v24, v112, v113
    v_cvt_pk_bf16_f32 v25, v114, v115
    v_lshlrev_b32 v112, 16, v24
    v_and_b32 v113, 0xffff0000, v24
    v_lshlrev_b32 v114, 16, v25
    v_and_b32 v115, 0xffff0000, v25
    v_max_f32 v24, v112, v113
    v_max3_f32 v24, v24, v114, v115
    v_mov_b32 v25, v24
    s_nop 1
    v_permlane16_swap_b32 v24, v25
    v_max_f32 v24, v24, v25
    v_mov_b32 v25, v24
    s_nop 1
    v_permlane32_swap_b32 v24, v25
    v_max_f32 v24, v24, v25
    v_mul_f32 v24, s58, v24
    v_max_f32 v24, v120, v24
    v_sub_f32 v122, v120, v24
    v_exp_f32 v122, v122
    v_mov_b32 v120, v24
    v_fma_f32 v123, v112, s58, -v120
    v_fma_f32 v124, v113, s58, -v120
    v_fma_f32 v125, v114, s58, -v120
    v_fma_f32 v126, v115, s58, -v120
    v_exp_f32 v123, v123
    v_exp_f32 v124, v124
    v_exp_f32 v125, v125
    v_exp_f32 v126, v126
    v_mul_f32 v121, v121, v122
    v_mul_f32 v116, v116, v122
    v_mul_f32 v117, v117, v122
    v_mul_f32 v118, v118, v122
    v_mul_f32 v119, v119, v122
    v_add_f32 v121, v121, v123
    v_add_f32 v121, v121, v124
    v_add_f32 v121, v121, v125
    v_add_f32 v121, v121, v126
    v_cvt_pk_bf16_f32 v24, v123, v123
    v_and_b32 v8, v24, v28
    v_and_b32 v9, v24, v29
    v_and_b32 v10, v24, v30
    v_and_b32 v11, v24, v31
    v_cvt_pk_bf16_f32 v24, v124, v124
    v_and_b32 v12, v24, v28
    v_and_b32 v13, v24, v29
    v_and_b32 v14, v24, v30
    v_and_b32 v15, v24, v31
    v_cvt_pk_bf16_f32 v24, v125, v125
    v_and_b32 v16, v24, v28
    v_and_b32 v17, v24, v29
    v_and_b32 v18, v24, v30
    v_and_b32 v19, v24, v31
    v_cvt_pk_bf16_f32 v24, v126, v126
    v_and_b32 v20, v24, v28
    v_and_b32 v21, v24, v29
    v_and_b32 v22, v24, v30
    v_and_b32 v23, v24, v31
    s_waitcnt vmcnt(0)
    v_mfma_f32_16x16x32_bf16 v[116:119], v[64:67], v[8:11], v[116:119]
    v_mfma_f32_16x16x32_bf16 v[116:119], v[68:71], v[12:15], v[116:119]
    v_mfma_f32_16x16x32_bf16 v[116:119], v[72:75], v[16:19], v[116:119]
    v_mfma_f32_16x16x32_bf16 v[116:119], v[76:79], v[20:23], v[116:119]
    v_mov_b32 v25, v121
    s_nop 1
    v_permlane16_swap_b32 v121, v25
    v_add_f32 v121, v121, v25
    v_mov_b32 v25, v121
    s_nop 1
    v_permlane32_swap_b32 v121, v25
    v_add_f32 v121, v121, v25
    s_lshl_b32 s88, s3, 9
    v_lshlrev_b32 v5, 7, v4
    v_lshl_add_u32 v5, v3, 2, v5
    v_add_u32 v5, s88, v5
    s_mov_b32 exec_lo, 0x00ff00ff
    s_mov_b32 exec_hi, 0x00ff00ff
    ds_write_b32 v5, v116 offset:0
    ds_write_b32 v5, v117 offset:32
    ds_write_b32 v5, v118 offset:64
    ds_write_b32 v5, v119 offset:96
    s_mov_b64 exec, 1
    s_lshl_b32 s88, s3, 3
    v_mov_b32 v5, s88
    v_mov_b32 v26, v120
    v_mov_b32 v27, v121
    ds_write_b64 v5, v[26:27] offset:4096
    s_mov_b64 exec, -1
    s_waitcnt lgkmcnt(0)
    s_mov_b64 exec, 1
    ds_add_u32 v133, v132 offset:40
    s_mov_b64 exec, -1
    s_cmp_eq_u32 s3, 5
    s_cbranch_scc0 L_noev_42
    s_mov_b32 s96, 0
L_wc_43:
    ds_read_b32 v5, v133
    s_waitcnt lgkmcnt(0)
    v_readfirstlane_b32 s88, v5
    s_cmp_gt_u32 s88, 48
    s_cbranch_scc1 L_wcd_44
    s_sleep 3
    s_add_u32 s96, s96, 1
    s_cmp_lt_u32 s96, 0x100000
    s_cbranch_scc1 L_wc_43
L_wcd_44:
    s_memrealtime s[98:99]
    s_waitcnt lgkmcnt(0)
    s_min_u32 s88, s98, 0xfffffffe
    v_mov_b32 v228, s88
    s_mov_b32 s96, 0
L_wc_45:
    ds_read_b32 v5, v133
    s_waitcnt lgkmcnt(0)
    v_readfirstlane_b32 s88, v5
    s_cmp_gt_u32 s88, 40
    s_cbranch_scc1 L_wcd_46
    s_sleep 3
    s_add_u32 s96, s96, 1
    s_cmp_lt_u32 s96, 0x100000
    s_cbranch_scc1 L_wc_45
L_wcd_46:
    s_mov_b32 s96, 0
L_init_47:
    buffer_load_dword v7, v141, s[44:47], 0 offen sc1
    s_waitcnt vmcnt(0)
    v_cmp_gt_u32 vcc, 256, v7
    s_cbranch_vccz L_initd_48
    s_add_u32 s96, s96, 1
    s_cmp_lt_u32 s96, 0x40000
    s_cbranch_scc1 L_init_47
L_initd_48:
    ds_write_b32 v133, v132 offset:12
    s_mov_b32 s96, 0
L_wc_49:
    ds_read_b32 v5, v133
    s_waitcnt lgkmcnt(0)
    v_readfirstlane_b32 s88, v5
    s_cmp_gt_u32 s88, 192
    s_cbranch_scc1 L_wcd_50
    s_sleep 3
    s_add_u32 s96, s96, 1
    s_cmp_lt_u32 s96, 0x100000
    s_cbranch_scc1 L_wc_49
L_wcd_50:
    s_memrealtime s[98:99]
    s_waitcnt lgkmcnt(0)
    s_min_u32 s88, s98, 0xfffffffe
    v_mov_b32 v229, s88
    ds_write_b64 v133, v[228:229] offset:24
    s_lshl_b32 s88, s54, 7
    s_lshl_b32 s89, s52, 3
    s_add_u32 s88, s88, s89
    s_add_u32 s88, s88, 0x1f0000
    s_mov_b64 exec, 1
    buffer_store_dwordx2 v[228:229], v141, s[20:23], s88 offen sc1
    s_mov_b64 exec, -1
    s_mov_b32 s96, 0
L_wf_51:
    ds_read_b32 v5, v133 offset:12
    s_waitcnt lgkmcnt(0)
    v_readfirstlane_b32 s88, v5
    s_cmp_lg_u32 s88, 0
    s_cbranch_scc1 L_wfd_52
    s_sleep 2
    s_add_u32 s96, s96, 1
    s_cmp_lt_u32 s96, 0x100000
    s_cbranch_scc1 L_wf_51
L_wfd_52:
    s_mov_b32 s96, 0
L_wf_53:
    ds_read_b32 v5, v133 offset:28
    s_waitcnt lgkmcnt(0)
    v_readfirstlane_b32 s88, v5
    s_cmp_lg_u32 s88, 0
    s_cbranch_scc1 L_wfd_54
    s_sleep 2
    s_add_u32 s96, s96, 1
    s_cmp_lt_u32 s96, 0x100000
    s_cbranch_scc1 L_wf_53
L_wfd_54:
    ds_read_b64 v[216:217], v133 offset:24
    s_lshl_b32 s92, s54, 7
    s_xor_b32 s93, s52, 1
    s_lshl_b32 s93, s93, 3
    s_add_u32 s92, s92, s93
    s_add_u32 s92, s92, 0x1f0000
    s_mov_b32 s96, 0
L_pT_55:
    buffer_load_dwordx2 v[218:219], v141, s[20:23], s92 offen sc1
    s_waitcnt vmcnt(0)
    v_max_u32 v220, v218, v219
    v_cmp_eq_u32 vcc, -1, v220
    s_cbranch_vccz L_pTd_56
    s_add_u32 s96, s96, 1
    s_cmp_lt_u32 s96, 0x40000
    s_cbranch_scc1 L_pT_55
L_pTd_56:
    s_waitcnt lgkmcnt(0)
    s_cmp_eq_u32 s52, 0
    s_cselect_b64 vcc, -1, 0
    v_cndmask_b32 v220, v218, v216, vcc
    v_cndmask_b32 v221, v219, v217, vcc
    v_cndmask_b32 v222, v216, v218, vcc
    v_cndmask_b32 v223, v217, v219, vcc
    v_sub_u32 v224, v221, v220
    v_sub_u32 v225, v223, v222
    v_sub_u32 v226, v223, v221
    v_cvt_f32_u32 v224, v224
    v_cvt_f32_u32 v225, v225
    v_cvt_f32_i32 v226, v226
    v_mul_f32 v224, 0x3a638e39, v224
    s_lshr_b32 s92, s54, 3
    s_cmp_lt_u32 s92, 2
    s_mov_b32 s93, 0x3a638e39
    s_cselect_b32 s92, 0x3a638e39, s93
    v_mul_f32 v225, s92, v225
    v_mov_b32 v227, 0x44800000
    v_fma_f32 v226, v227, v225, v226
    v_add_f32 v224, v224, v225
    v_rcp_f32 v224, v224
    s_nop 0
    v_mul_f32 v226, v226, v224
    v_mov_b32 v227, 0xc4060000
    v_add_f32 v226, v226, v227
    v_mul_f32 v226, 0x3e000000, v226
    v_rndne_f32 v226, v226
    v_mov_b32 v227, 0x42200000
    v_med3_f32 v226, v226, -v227, v227
    v_cvt_i32_f32 v226, v226
    v_sub_u32 v227, 0, v226
    v_cndmask_b32 v226, v227, v226, vcc
    v_add_u32 v227, 256, v226
    ds_write_b32 v133, v226 offset:36
    s_waitcnt lgkmcnt(0)
    ds_write_b32 v133, v227 offset:32
L_noev_42:
    s_cmp_lt_u32 s53, 144
    s_cbranch_scc0 L_tailw
    s_mov_b32 s96, 0
L_svw_57:
    ds_read_b32 v5, v133 offset:32
    ds_read_b32 v6, v133
    s_waitcnt lgkmcnt(0)
    v_readfirstlane_b32 s88, v5
    v_readfirstlane_b32 s89, v6
    s_add_u32 s89, s89, 6
    s_cmp_eq_u32 s88, 0
    s_cselect_b32 s88, -1, s88
    s_cmp_ge_u32 s89, s88
    s_cbranch_scc1 L_svd_58
    s_sleep 16
    s_add_u32 s96, s96, 1
    s_cmp_lt_u32 s96, 0x100000
    s_cbranch_scc1 L_svw_57
L_svd_58:
    s_add_u32 s61, s3, 13
L_dl_59:
    s_cmp_lt_u32 s61, 18
    s_cbranch_scc0 L_hgu_60
    s_lshl_b32 s89, s61, 6
    v_add_u32 v5, s89, v2
    s_mov_b32 s90, 7282
    v_mul_lo_u32 v6, v5, s90
    v_lshrrev_b32 v6, 16, v6
    v_mul_u32_u24 v7, 9, v6
    v_sub_u32 v7, v5, v7
    v_mul_u32_u24 v6, 1152, v6
    v_lshl_add_u32 v6, v7, 4, v6
    s_mul_i32 s90, s48, 147456
    s_mul_i32 s91, s49, 144
    s_add_u32 s90, s90, s91
    s_lshl_b32 s89, s61, 10
    s_add_u32 m0, s89, 19968
    s_nop 0
    buffer_load_dwordx4 v6, s[24:27], s90 offen nt lds
    s_branch L_hx_62
L_hgu_60:
    s_cmp_lt_u32 s61, 90
    s_cbranch_scc0 L_hdn_61
    s_sub_u32 s89, s61, 18
    s_lshl_b32 s90, s89, 10
    s_add_u32 m0, s90, 38656
    s_cmp_lt_u32 s89, 36
    s_cbranch_scc0 L_hu_63
    s_mul_i32 s90, s89, 147456
    buffer_load_dwordx4 v134, s[28:31], s90 offen nt lds
    s_branch L_hx_62
L_hu_63:
    s_sub_u32 s89, s89, 36
    s_mul_i32 s90, s89, 147456
    buffer_load_dwordx4 v134, s[32:35], s90 offen nt lds
    s_branch L_hx_62
L_hdn_61:
    s_sub_u32 s89, s61, 90
    s_lshl_b32 s89, s89, 10
    s_mul_i32 s90, s53, 36864
    s_add_u32 s90, s90, s89
    s_add_u32 m0, s89, 112384
    s_nop 0
    buffer_load_dwordx4 v135, s[36:39], s90 offen nt lds
L_hx_62:
    s_add_u32 s61, s61, 3
    s_cmp_lt_u32 s61, 126
    s_cbranch_scc1 L_dl_59
    s_branch L_phaseM
L_go_41:
L_loop:
    s_mov_b64 exec, 1
    ds_add_rtn_u32 v127, v133, v132 offset:0
    s_mov_b64 exec, -1
    s_waitcnt vmcnt(4)
    v_mfma_f32_16x16x32_bf16 v[112:115], v[48:51], v[32:35], 0
    v_mfma_f32_16x16x32_bf16 v[112:115], v[52:55], v[36:39], v[112:115]
    v_mfma_f32_16x16x32_bf16 v[112:115], v[56:59], v[40:43], v[112:115]
    v_mfma_f32_16x16x32_bf16 v[112:115], v[60:63], v[44:47], v[112:115]
    s_waitcnt lgkmcnt(0)
    v_readfirstlane_b32 s55, v127
    s_cmp_lt_u32 s55, 216
    s_cbranch_scc0 L_late_65
    s_lshr_b32 s88, s55, 3
    s_lshl_b32 s88, s88, 4
    s_and_b32 s89, s55, 7
    s_add_u32 s88, s88, s89
    s_lshl_b32 s89, s52, 3
    s_add_u32 s88, s88, s89
    s_lshl_b32 s56, s88, 12
    s_branch L_join_66
L_late_65:
    s_cmp_lt_u32 s97, 65536
    s_cbranch_scc1 L_known_67
    s_mov_b32 s96, 0
L_wf_68:
    ds_read_b32 v5, v133 offset:32
    s_waitcnt lgkmcnt(0)
    v_readfirstlane_b32 s88, v5
    s_cmp_lg_u32 s88, 0
    s_cbranch_scc1 L_wfd_69
    s_sleep 2
    s_add_u32 s96, s96, 1
    s_cmp_lt_u32 s96, 0x100000
    s_cbranch_scc1 L_wf_68
L_wfd_69:
    s_mov_b32 s97, s88
    ds_read_b32 v5, v133 offset:36
    s_waitcnt lgkmcnt(0)
    v_readfirstlane_b32 s100, v5
L_known_67:
    s_sub_u32 s90, s55, s100
    s_xor_b32 s91, s52, 1
    s_cmp_ge_u32 s55, 256
    s_cselect_b32 s90, s90, s55
    s_cselect_b32 s91, s91, s52
    s_lshr_b32 s88, s90, 3
    s_lshl_b32 s88, s88, 4
    s_and_b32 s89, s90, 7
    s_add_u32 s88, s88, s89
    s_lshl_b32 s89, s91, 3
    s_add_u32 s88, s88, s89
    s_cmp_lt_u32 s55, s97
    s_cselect_b32 s88, s88, 0x200
    s_lshl_b32 s56, s88, 12
L_join_66:
    buffer_load_dwordx4 v[48:51], v128, s[8:11], s56 offen offset:0 nt
    buffer_load_dwordx4 v[52:55], v128, s[8:11], s56 offen offset:64 nt
    buffer_load_dwordx4 v[56:59], v128, s[8:11], s56 offen offset:128 nt
    buffer_load_dwordx4 v[60:63], v128, s[8:11], s56 offen offset:192 nt
    v_cvt_pk_bf16_f32 v24, v112, v113
    v_cvt_pk_bf16_f32 v25, v114, v115
    v_lshlrev_b32 v112, 16, v24
    v_and_b32 v113, 0xffff0000, v24
    v_lshlrev_b32 v114, 16, v25
    v_and_b32 v115, 0xffff0000, v25
    v_mul_f32 v112, s57, v112
    v_mul_f32 v113, s57, v113
    v_mul_f32 v114, s57, v114
    v_mul_f32 v115, s57, v115
    v_cvt_pk_bf16_f32 v24, v112, v113
    v_cvt_pk_bf16_f32 v25, v114, v115
    v_lshlrev_b32 v112, 16, v24
    v_and_b32 v113, 0xffff0000, v24
    v_lshlrev_b32 v114, 16, v25
    v_and_b32 v115, 0xffff0000, v25
    v_max_f32 v24, v112, v113
    v_max3_f32 v24, v24, v114, v115
    v_mov_b32 v25, v24
    s_nop 1
    v_permlane16_swap_b32 v24, v25
    v_max_f32 v24, v24, v25
    v_mov_b32 v25, v24
    s_nop 1
    v_permlane32_swap_b32 v24, v25
    v_max_f32 v24, v24, v25
    v_mul_f32 v24, s58, v24
    v_max_f32 v24, v120, v24
    v_sub_f32 v122, v120, v24
    v_exp_f32 v122, v122
    v_mov_b32 v120, v24
    v_fma_f32 v123, v112, s58, -v120
    v_fma_f32 v124, v113, s58, -v120
    v_fma_f32 v125, v114, s58, -v120
    v_fma_f32 v126, v115, s58, -v120
    v_exp_f32 v123, v123
    v_exp_f32 v124, v124
    v_exp_f32 v125, v125
    v_exp_f32 v126, v126
    v_mul_f32 v121, v121, v122
    v_mul_f32 v116, v116, v122
    v_mul_f32 v117, v117, v122
    v_mul_f32 v118, v118, v122
    v_mul_f32 v119, v119, v122
    v_add_f32 v121, v121, v123
    v_add_f32 v121, v121, v124
    v_add_f32 v121, v121, v125
    v_add_f32 v121, v121, v126
    v_cvt_pk_bf16_f32 v24, v123, v123
    v_and_b32 v8, v24, v28
    v_and_b32 v9, v24, v29
    v_and_b32 v10, v24, v30
    v_and_b32 v11, v24, v31
    v_cvt_pk_bf16_f32 v24, v124, v124
    v_and_b32 v12, v24, v28
    v_and_b32 v13, v24, v29
    v_and_b32 v14, v24, v30
    v_and_b32 v15, v24, v31
    v_cvt_pk_bf16_f32 v24, v125, v125
    v_and_b32 v16, v24, v28
    v_and_b32 v17, v24, v29
    v_and_b32 v18, v24, v30
    v_and_b32 v19, v24, v31
    v_cvt_pk_bf16_f32 v24, v126, v126
    v_and_b32 v20, v24, v28
    v_and_b32 v21, v24, v29
    v_and_b32 v22, v24, v30
    v_and_b32 v23, v24, v31
    s_waitcnt vmcnt(4)
    v_mfma_f32_16x16x32_bf16 v[116:119], v[64:67], v[8:11], v[116:119]
    v_mfma_f32_16x16x32_bf16 v[116:119], v[68:71], v[12:15], v[116:119]
    v_mfma_f32_16x16x32_bf16 v[116:119], v[72:75], v[16:19], v[116:119]
    v_mfma_f32_16x16x32_bf16 v[116:119], v[76:79], v[20:23], v[116:119]
    buffer_load_dwordx4 v[64:67], v129, s[12:15], s56 offen offset:0 nt
    buffer_load_dwordx4 v[68:71], v129, s[12:15], s56 offen offset:256 nt
    buffer_load_dwordx4 v[72:75], v129, s[12:15], s56 offen offset:512 nt
    buffer_load_dwordx4 v[76:79], v129, s[12:15], s56 offen offset:768 nt
    s_cmp_lt_u32 s55, s97
    s_cbranch_scc1 L_loop
L_loopx:
    v_mov_b32 v25, v121
    s_nop 1
    v_permlane16_swap_b32 v121, v25
    v_add_f32 v121, v121, v25
    v_mov_b32 v25, v121
    s_nop 1
    v_permlane32_swap_b32 v121, v25
    v_add_f32 v121, v121, v25
    s_lshl_b32 s88, s3, 9
    v_lshlrev_b32 v5, 7, v4
    v_lshl_add_u32 v5, v3, 2, v5
    v_add_u32 v5, s88, v5
    s_mov_b32 exec_lo, 0x00ff00ff
    s_mov_b32 exec_hi, 0x00ff00ff
    ds_write_b32 v5, v116 offset:0
    ds_write_b32 v5, v117 offset:32
    ds_write_b32 v5, v118 offset:64
    ds_write_b32 v5, v119 offset:96
    s_mov_b64 exec, 1
    s_lshl_b32 s88, s3, 3
    v_mov_b32 v5, s88
    v_mov_b32 v26, v120
    v_mov_b32 v27, v121
    ds_write_b64 v5, v[26:27] offset:4096
    s_mov_b64 exec, -1
    s_waitcnt lgkmcnt(0)
    s_mov_b64 exec, 1
    ds_add_u32 v133, v132 offset:40
    s_mov_b64 exec, -1
    s_cmp_eq_u32 s3, 0
    s_cbranch_scc0 L_nwait_70
    s_mov_b32 s96, 0
L_dw_71:
    ds_read_b32 v5, v133 offset:40
    s_waitcnt lgkmcnt(0)
    v_readfirstlane_b32 s88, v5
    s_cmp_ge_u32 s88, 8
    s_cbranch_scc1 L_dwd_72
    s_add_u32 s96, s96, 1
    s_cmp_lt_u32 s96, 0x100000
    s_cbranch_scc1 L_dw_71
L_dwd_72:
L_nwait_70:
    s_cmp_eq_u32 s3, 0
    s_cbranch_scc0 L_phaseW
    v_and_b32 v5, 31, v2
    v_lshlrev_b32 v5, 4, v5
    ds_read_b128 v[8:11], v5 offset:0
    ds_read_b128 v[12:15], v5 offset:512
    ds_read_b128 v[16:19], v5 offset:1024
    ds_read_b128 v[20:23], v5 offset:1536
    ds_read_b128 v[24:27], v5 offset:2048
    ds_read_b128 v[28:31], v5 offset:2560
    ds_read_b128 v[32:35], v5 offset:3072
    ds_read_b128 v[36:39], v5 offset:3584
    ds_read_b64 v[216:217], v141 offset:4096
    ds_read_b64 v[218:219], v141 offset:4104
    ds_read_b64 v[220:221], v141 offset:4112
    ds_read_b64 v[222:223], v141 offset:4120
    ds_read_b64 v[224:225], v141 offset:4128
    ds_read_b64 v[226:227], v141 offset:4136
    ds_read_b64 v[228:229], v141 offset:4144
    ds_read_b64 v[230:231], v141 offset:4152
    s_waitcnt lgkmcnt(0)
    v_max3_f32 v40, v216, v218, v220
    v_max3_f32 v40, v40, v222, v224
    v_max3_f32 v40, v40, v226, v228
    v_max_f32 v40, v40, v230
    v_sub_f32 v216, v216, v40
    v_sub_f32 v218, v218, v40
    v_sub_f32 v220, v220, v40
    v_sub_f32 v222, v222, v40
    v_sub_f32 v224, v224, v40
    v_sub_f32 v226, v226, v40
    v_sub_f32 v228, v228, v40
    v_sub_f32 v230, v230, v40
    v_exp_f32 v216, v216
    v_exp_f32 v218, v218
    v_exp_f32 v220, v220
    v_exp_f32 v222, v222
    v_exp_f32 v224, v224
    v_exp_f32 v226, v226
    v_exp_f32 v228, v228
    v_exp_f32 v230, v230
    v_mul_f32 v41, v216, v217
    v_mul_f32 v232, v216, v8
    v_mul_f32 v233, v216, v9
    v_mul_f32 v234, v216, v10
    v_mul_f32 v235, v216, v11
    v_fmac_f32 v41, v218, v219
    v_fmac_f32 v232, v218, v12
    v_fmac_f32 v233, v218, v13
    v_fmac_f32 v234, v218, v14
    v_fmac_f32 v235, v218, v15
    v_fmac_f32 v41, v220, v221
    v_fmac_f32 v232, v220, v16
    v_fmac_f32 v233, v220, v17
    v_fmac_f32 v234, v220, v18
    v_fmac_f32 v235, v220, v19
    v_fmac_f32 v41, v222, v223
    v_fmac_f32 v232, v222, v20
    v_fmac_f32 v233, v222, v21
    v_fmac_f32 v234, v222, v22
    v_fmac_f32 v235, v222, v23
    v_fmac_f32 v41, v224, v225
    v_fmac_f32 v232, v224, v24
    v_fmac_f32 v233, v224, v25
    v_fmac_f32 v234, v224, v26
    v_fmac_f32 v235, v224, v27
    v_fmac_f32 v41, v226, v227
    v_fmac_f32 v232, v226, v28
    v_fmac_f32 v233, v226, v29
    v_fmac_f32 v234, v226, v30
    v_fmac_f32 v235, v226, v31
    v_fmac_f32 v41, v228, v229
    v_fmac_f32 v232, v228, v32
    v_fmac_f32 v233, v228, v33
    v_fmac_f32 v234, v228, v34
    v_fmac_f32 v235, v228, v35
    v_fmac_f32 v41, v230, v231
    v_fmac_f32 v232, v230, v36
    v_fmac_f32 v233, v230, v37
    v_fmac_f32 v234, v230, v38
    v_fmac_f32 v235, v230, v39
    v_cmp_eq_u32 vcc, 32, v2
    s_nop 1
    v_cndmask_b32 v232, v232, v40, vcc
    v_cndmask_b32 v233, v233, v41, vcc
    v_min_u32 v232, s59, v232
    v_min_u32 v233, s59, v233
    v_min_u32 v234, s59, v234
    v_min_u32 v235, s59, v235
    s_lshl_b32 s88, s51, 3
    s_lshl_b32 s89, s50, 1
    s_add_u32 s88, s88, s89
    s_add_u32 s88, s88, s52
    s_lshl_b32 s88, s88, 10
    s_add_u32 s88, s88, 0x0
    v_lshlrev_b32 v5, 4, v2
    s_mov_b32 exec_lo, -1
    s_mov_b32 exec_hi, 1
    buffer_store_dwordx4 v[232:235], v5, s[20:23], s88 offen sc1
    s_mov_b64 exec, -1
L_phaseW:
    s_cmp_lt_u32 s53, 144
    s_cbranch_scc1 L_phaseR
L_tailw:
    s_add_u32 s88, s3, 7
    s_and_b32 s88, s88, 7
    s_lshr_b32 s77, s88, 1
    s_and_b32 s78, s88, 1
    s_cmp_lt_u32 s77, s76
    s_cbranch_scc0 L_fin
    s_mov_b32 s96, 0
L_dw_73:
    ds_read_b32 v5, v133 offset:40
    s_waitcnt lgkmcnt(0)
    v_readfirstlane_b32 s88, v5
    s_cmp_ge_u32 s88, 8
    s_cbranch_scc1 L_dwd_74
    s_sleep 4
    s_add_u32 s96, s96, 1
    s_cmp_lt_u32 s96, 0x100000
    s_cbranch_scc1 L_dw_73
L_dwd_74:
    s_sub_u32 s79, s49, 4
    s_cmp_eq_u32 s77, 0
    s_cselect_b32 s79, s49, s79
    s_cmp_eq_u32 s77, 2
    s_cselect_b32 s79, 4, s79
    s_cmp_eq_u32 s77, 3
    s_cselect_b32 s79, 0, s79
    v_lshrrev_b32 v6, 2, v3
    v_lshl_add_u32 v6, v4, 3, v6
    v_and_b32 v7, 3, v3
    v_lshlrev_b32 v7, 3, v7
    v_mul_u32_u24 v5, 144, v6
    v_add_u32 v5, v5, v7
    s_mul_i32 s88, s77, 18688
    v_add_u32 v5, s88, v5
    ds_read_b64_tr_b16 v[144:145], v5 offset:19968
    ds_read_b64_tr_b16 v[146:147], v5 offset:20544
    ds_read_b64_tr_b16 v[148:149], v5 offset:24576
    ds_read_b64_tr_b16 v[150:151], v5 offset:25152
    ds_read_b64_tr_b16 v[152:153], v5 offset:29184
    ds_read_b64_tr_b16 v[154:155], v5 offset:29760
    ds_read_b64_tr_b16 v[156:157], v5 offset:33792
    ds_read_b64_tr_b16 v[158:159], v5 offset:34368
    ds_read_b64_tr_b16 v[160:161], v5 offset:20000
    ds_read_b64_tr_b16 v[162:163], v5 offset:20576
    ds_read_b64_tr_b16 v[164:165], v5 offset:24608
    ds_read_b64_tr_b16 v[166:167], v5 offset:25184
    ds_read_b64_tr_b16 v[168:169], v5 offset:29216
    ds_read_b64_tr_b16 v[170:171], v5 offset:29792
    ds_read_b64_tr_b16 v[172:173], v5 offset:33824
    ds_read_b64_tr_b16 v[174:175], v5 offset:34400
    ds_read_b64_tr_b16 v[176:177], v5 offset:20032
    ds_read_b64_tr_b16 v[178:179], v5 offset:20608
    ds_read_b64_tr_b16 v[180:181], v5 offset:24640
    ds_read_b64_tr_b16 v[182:183], v5 offset:25216
    ds_read_b64_tr_b16 v[184:185], v5 offset:29248
    ds_read_b64_tr_b16 v[186:187], v5 offset:29824
    ds_read_b64_tr_b16 v[188:189], v5 offset:33856
    ds_read_b64_tr_b16 v[190:191], v5 offset:34432
    ds_read_b64_tr_b16 v[192:193], v5 offset:20064
    ds_read_b64_tr_b16 v[194:195], v5 offset:20640
    ds_read_b64_tr_b16 v[196:197], v5 offset:24672
    ds_read_b64_tr_b16 v[198:199], v5 offset:25248
    ds_read_b64_tr_b16 v[200:201], v5 offset:29280
    ds_read_b64_tr_b16 v[202:203], v5 offset:29856
    ds_read_b64_tr_b16 v[204:205], v5 offset:33888
    ds_read_b64_tr_b16 v[206:207], v5 offset:34464
    ds_read_b64_tr_b16 v[208:209], v5 offset:20096
    ds_read_b64_tr_b16 v[210:211], v5 offset:20672
    ds_read_b64_tr_b16 v[212:213], v5 offset:24704
    ds_read_b64_tr_b16 v[214:215], v5 offset:25280
    ds_read_b64_tr_b16 v[216:217], v5 offset:29312
    ds_read_b64_tr_b16 v[218:219], v5 offset:29888
    ds_read_b64_tr_b16 v[220:221], v5 offset:33920
    ds_read_b64_tr_b16 v[222:223], v5 offset:34496
    v_lshrrev_b32 v5, 5, v2
    s_lshl_b32 s88, s78, 1
    v_add_u32 v5, s88, v5
    v_and_b32 v6, 31, v2
    v_lshlrev_b32 v7, 11, v5
    v_lshl_add_u32 v8, v6, 4, v7
    s_lshl_b32 s88, s48, 13
    s_add_u32 s88, s88, 0x0
    v_and_b32 v14, 1, v2
    s_mov_b32 s92, s78
    s_lshl_b32 s89, s92, 1
    v_add_u32 v14, s89, v14
    v_mul_u32_u24 v14, 288, v14
    v_lshl_add_u32 v14, v4, 4, v14
    v_mul_u32_u24 v15, 288, v5
    v_lshl_add_u32 v15, v6, 3, v15
    s_mul_i32 s93, s77, 1152
    v_add_u32 v14, s93, v14
    v_add_u32 v15, s93, v15
    s_lshl_b32 s90, s79, 5
    s_add_u32 s90, s90, s48
    s_mul_i32 s90, s90, 1152
    s_lshl_b32 s91, s92, 3
    s_add_u32 s90, s90, s91
    s_add_u32 s90, s90, 0x40000
    v_lshlrev_b32 v16, 4, v2
    s_mov_b32 s96, 0
    buffer_load_dwordx4 v[224:227], v8, s[20:23], s88 offen sc1
    buffer_load_dwordx4 v[228:231], v8, s[20:23], s88 offen offset:1024 sc1
    buffer_load_dwordx2 v[232:233], v7, s[20:23], s88 offen offset:512 sc1
    buffer_load_dwordx2 v[234:235], v7, s[20:23], s88 offen offset:1536 sc1
    s_sleep 4
L_pW_75:
    buffer_load_dwordx4 v[236:239], v8, s[20:23], s88 offen sc1
    buffer_load_dwordx4 v[240:243], v8, s[20:23], s88 offen offset:1024 sc1
    buffer_load_dwordx2 v[244:245], v7, s[20:23], s88 offen offset:512 sc1
    buffer_load_dwordx2 v[246:247], v7, s[20:23], s88 offen offset:1536 sc1
    s_waitcnt vmcnt(4)
    v_max_u32 v23, v224, v225
    v_max3_u32 v23, v23, v226, v227
    v_max3_u32 v23, v23, v228, v229
    v_max3_u32 v23, v23, v230, v231
    v_max3_u32 v23, v23, v232, v233
    v_max3_u32 v23, v23, v234, v235
    v_cmp_eq_u32 vcc, -1, v23
    s_cbranch_vccz L_pWa_76
    buffer_load_dwordx4 v[224:227], v8, s[20:23], s88 offen sc1
    buffer_load_dwordx4 v[228:231], v8, s[20:23], s88 offen offset:1024 sc1
    buffer_load_dwordx2 v[232:233], v7, s[20:23], s88 offen offset:512 sc1
    buffer_load_dwordx2 v[234:235], v7, s[20:23], s88 offen offset:1536 sc1
    s_waitcnt vmcnt(4)
    v_max_u32 v23, v236, v237
    v_max3_u32 v23, v23, v238, v239
    v_max3_u32 v23, v23, v240, v241
    v_max3_u32 v23, v23, v242, v243
    v_max3_u32 v23, v23, v244, v245
    v_max3_u32 v23, v23, v246, v247
    v_cmp_eq_u32 vcc, -1, v23
    s_cbranch_vccz L_pWb_77
    s_add_u32 s96, s96, 1
    s_cmp_lt_u32 s96, 0x40000
    s_cbranch_scc1 L_pW_75
L_pWa_76:
    v_max_f32 v22, v232, v234
    v_sub_f32 v18, v232, v22
    v_sub_f32 v20, v234, v22
    v_exp_f32 v18, v18
    v_exp_f32 v20, v20
    v_mul_f32 v22, v18, v233
    v_fmac_f32 v22, v20, v235
    v_rcp_f32 v22, v22
    s_nop 0
    v_mul_f32 v18, v18, v22
    v_mul_f32 v20, v20, v22
    v_mul_f32 v10, v224, v18
    v_fmac_f32 v10, v228, v20
    v_mul_f32 v11, v225, v18
    v_fmac_f32 v11, v229, v20
    v_mul_f32 v12, v226, v18
    v_fmac_f32 v12, v230, v20
    v_mul_f32 v13, v227, v18
    v_fmac_f32 v13, v231, v20
    s_branch L_pWx_78
L_pWb_77:
    v_max_f32 v22, v244, v246
    v_sub_f32 v18, v244, v22
    v_sub_f32 v20, v246, v22
    v_exp_f32 v18, v18
    v_exp_f32 v20, v20
    v_mul_f32 v22, v18, v245
    v_fmac_f32 v22, v20, v247
    v_rcp_f32 v22, v22
    s_nop 0
    v_mul_f32 v18, v18, v22
    v_mul_f32 v20, v20, v22
    v_mul_f32 v10, v236, v18
    v_fmac_f32 v10, v240, v20
    v_mul_f32 v11, v237, v18
    v_fmac_f32 v11, v241, v20
    v_mul_f32 v12, v238, v18
    v_fmac_f32 v12, v242, v20
    v_mul_f32 v13, v239, v18
    v_fmac_f32 v13, v243, v20
L_pWx_78:
    v_cvt_pk_bf16_f32 v10, v10, v11
    v_cvt_pk_bf16_f32 v11, v12, v13
    ds_write_b64 v15, v[10:11] offset:5504
    s_waitcnt lgkmcnt(0)
    ds_read_b128 v[24:27], v14 offset:5504
    ds_read_b128 v[28:31], v14 offset:5568
    ds_read_b128 v[32:35], v14 offset:5632
    ds_read_b128 v[36:39], v14 offset:5696
    s_waitcnt lgkmcnt(0)
    v_mfma_f32_16x16x32_bf16 v[40:43], v[24:27], v[144:147], 0
    v_mfma_f32_16x16x32_bf16 v[44:47], v[24:27], v[160:163], 0
    v_mfma_f32_16x16x32_bf16 v[48:51], v[24:27], v[176:179], 0
    v_mfma_f32_16x16x32_bf16 v[52:55], v[24:27], v[192:195], 0
    v_mfma_f32_16x16x32_bf16 v[56:59], v[24:27], v[208:211], 0
    v_mfma_f32_16x16x32_bf16 v[40:43], v[28:31], v[148:151], v[40:43]
    v_mfma_f32_16x16x32_bf16 v[44:47], v[28:31], v[164:167], v[44:47]
    v_mfma_f32_16x16x32_bf16 v[48:51], v[28:31], v[180:183], v[48:51]
    v_mfma_f32_16x16x32_bf16 v[52:55], v[28:31], v[196:199], v[52:55]
    v_mfma_f32_16x16x32_bf16 v[56:59], v[28:31], v[212:215], v[56:59]
    v_mfma_f32_16x16x32_bf16 v[40:43], v[32:35], v[152:155], v[40:43]
    v_mfma_f32_16x16x32_bf16 v[44:47], v[32:35], v[168:171], v[44:47]
    v_mfma_f32_16x16x32_bf16 v[48:51], v[32:35], v[184:187], v[48:51]
    v_mfma_f32_16x16x32_bf16 v[52:55], v[32:35], v[200:203], v[52:55]
    v_mfma_f32_16x16x32_bf16 v[56:59], v[32:35], v[216:219], v[56:59]
    v_mfma_f32_16x16x32_bf16 v[40:43], v[36:39], v[156:159], v[40:43]
    v_mfma_f32_16x16x32_bf16 v[44:47], v[36:39], v[172:175], v[44:47]
    v_mfma_f32_16x16x32_bf16 v[48:51], v[36:39], v[188:191], v[48:51]
    v_mfma_f32_16x16x32_bf16 v[52:55], v[36:39], v[204:207], v[52:55]
    v_mfma_f32_16x16x32_bf16 v[56:59], v[36:39], v[220:223], v[56:59]
    s_nop 3
    v_min_u32 v40, s59, v40
    v_min_u32 v41, s59, v41
    v_min_u32 v44, s59, v44
    v_min_u32 v45, s59, v45
    v_min_u32 v48, s59, v48
    v_min_u32 v49, s59, v49
    v_min_u32 v52, s59, v52
    v_min_u32 v53, s59, v53
    v_min_u32 v56, s59, v56
    v_min_u32 v57, s59, v57
    s_mov_b64 exec, 0xffff
    buffer_store_dwordx2 v[40:41], v16, s[20:23], s90 offen offset:0 sc1
    buffer_store_dwordx2 v[44:45], v16, s[20:23], s90 offen offset:256 sc1
    buffer_store_dwordx2 v[48:49], v16, s[20:23], s90 offen offset:512 sc1
    buffer_store_dwordx2 v[52:53], v16, s[20:23], s90 offen offset:768 sc1
    s_mov_b64 exec, 0xff
    buffer_store_dwordx2 v[56:57], v16, s[20:23], s90 offen offset:1024 sc1
    s_mov_b64 exec, -1
    s_branch L_fin
L_phaseR:
    s_cmp_lt_u32 s53, 144
    s_cbranch_scc0 L_fin
    s_cmp_eq_u32 s3, 3
    s_cbranch_scc0 L_phaseM
    s_and_b32 s90, s2, 7
    s_lshr_b32 s91, s2, 3
    v_lshrrev_b32 v5, 2, v2
    v_and_b32 v6, 3, v2
    v_mul_u32_u24 v7, 1152, v5
    v_lshl_add_u32 v7, v6, 4, v7
    s_mul_i32 s92, s90, 36864
    s_lshl_b32 s93, s91, 6
    s_add_u32 s92, s92, s93
    s_add_u32 s92, s92, 0x40000
    s_add_u32 s93, s92, 18432
    s_mov_b32 s96, 0
    buffer_load_dwordx4 v[216:219], v7, s[20:23], s92 offen sc1
    buffer_load_dwordx4 v[220:223], v7, s[20:23], s93 offen sc1
    s_sleep 4
L_pR_79:
    buffer_load_dwordx4 v[224:227], v7, s[20:23], s92 offen sc1
    buffer_load_dwordx4 v[228:231], v7, s[20:23], s93 offen sc1
    s_waitcnt vmcnt(2)
    v_max_u32 v16, v216, v217
    v_max3_u32 v16, v16, v218, v219
    v_max3_u32 v16, v16, v220, v221
    v_max3_u32 v16, v16, v222, v223
    v_cmp_eq_u32 vcc, -1, v16
    s_cbranch_vccz L_pRa_80
    buffer_load_dwordx4 v[216:219], v7, s[20:23], s92 offen sc1
    buffer_load_dwordx4 v[220:223], v7, s[20:23], s93 offen sc1
    s_waitcnt vmcnt(2)
    v_max_u32 v16, v224, v225
    v_max3_u32 v16, v16, v226, v227
    v_max3_u32 v16, v16, v228, v229
    v_max3_u32 v16, v16, v230, v231
    v_cmp_eq_u32 vcc, -1, v16
    s_cbranch_vccz L_pRb_81
    s_add_u32 s96, s96, 1
    s_cmp_lt_u32 s96, 0x40000
    s_cbranch_scc1 L_pR_79
L_pRa_80:
    v_add_f32 v8, v216, v220
    v_add_f32 v9, v217, v221
    v_add_f32 v10, v218, v222
    v_add_f32 v11, v219, v223
    s_branch L_pRx_82
L_pRb_81:
    v_add_f32 v8, v224, v228
    v_add_f32 v9, v225, v229
    v_add_f32 v10, v226, v230
    v_add_f32 v11, v227, v231
L_pRx_82:
    v_add_f32_dpp v8, v8, v8 row_ror:4 row_mask:0xf bank_mask:0xf
    v_add_f32_dpp v9, v9, v9 row_ror:4 row_mask:0xf bank_mask:0xf
    v_add_f32_dpp v10, v10, v10 row_ror:4 row_mask:0xf bank_mask:0xf
    v_add_f32_dpp v11, v11, v11 row_ror:4 row_mask:0xf bank_mask:0xf
    v_add_f32_dpp v8, v8, v8 row_ror:8 row_mask:0xf bank_mask:0xf
    v_add_f32_dpp v9, v9, v9 row_ror:8 row_mask:0xf bank_mask:0xf
    v_add_f32_dpp v10, v10, v10 row_ror:8 row_mask:0xf bank_mask:0xf
    v_add_f32_dpp v11, v11, v11 row_ror:8 row_mask:0xf bank_mask:0xf
    v_mov_b32 v16, v8
    v_mov_b32 v17, v9
    v_mov_b32 v18, v10
    v_mov_b32 v19, v11
    v_permlane16_swap_b32 v8, v16
    v_permlane16_swap_b32 v9, v17
    v_permlane16_swap_b32 v10, v18
    v_permlane16_swap_b32 v11, v19
    v_add_f32 v8, v8, v16
    v_add_f32 v9, v9, v17
    v_add_f32 v10, v10, v18
    v_add_f32 v11, v11, v19
    v_mov_b32 v16, v8
    v_mov_b32 v17, v9
    v_mov_b32 v18, v10
    v_mov_b32 v19, v11
    v_permlane32_swap_b32 v8, v16
    v_permlane32_swap_b32 v9, v17
    v_permlane32_swap_b32 v10, v18
    v_permlane32_swap_b32 v11, v19
    v_add_f32 v8, v8, v16
    v_add_f32 v9, v9, v17
    v_add_f32 v10, v10, v18
    v_add_f32 v11, v11, v19
    v_cvt_pk_bf16_f32 v8, v8, v8
    v_and_b32 v8, 0xffff0000, v8
    v_cvt_pk_bf16_f32 v9, v9, v9
    v_and_b32 v9, 0xffff0000, v9
    v_cvt_pk_bf16_f32 v10, v10, v10
    v_and_b32 v10, 0xffff0000, v10
    v_cvt_pk_bf16_f32 v11, v11, v11
    v_and_b32 v11, 0xffff0000, v11
    v_lshlrev_b32 v136, 16, v136
    v_add_f32 v8, v8, v136
    v_lshlrev_b32 v137, 16, v137
    v_add_f32 v9, v9, v137
    v_lshlrev_b32 v138, 16, v138
    v_add_f32 v10, v10, v138
    v_lshlrev_b32 v139, 16, v139
    v_add_f32 v11, v11, v139
    v_cvt_pk_bf16_f32 v8, v8, v8
    v_and_b32 v8, 0xffff0000, v8
    v_cvt_pk_bf16_f32 v9, v9, v9
    v_and_b32 v9, 0xffff0000, v9
    v_cvt_pk_bf16_f32 v10, v10, v10
    v_and_b32 v10, 0xffff0000, v10
    v_cvt_pk_bf16_f32 v11, v11, v11
    v_and_b32 v11, 0xffff0000, v11
    v_min_u32 v8, s59, v8
    v_min_u32 v9, s59, v9
    v_min_u32 v10, s59, v10
    v_min_u32 v11, s59, v11
    s_mul_i32 s90, s90, 72
    s_lshl_b32 s91, s91, 2
    s_add_u32 s90, s90, s91
    s_lshl_b32 s90, s90, 4
    s_add_u32 s90, s90, 0x200000
    v_mul_u32_u24 v17, 9216, v5
    v_lshl_add_u32 v17, v6, 4, v17
    buffer_store_dwordx4 v[8:11], v17, s[20:23], s90 offen sc1
L_phaseM:
    s_cmp_ge_u32 s3, 5
    s_cbranch_scc0 L_nw_83
    s_waitcnt vmcnt(0)
L_nw_83:
    s_barrier
    s_and_b32 s88, s3, 3
    s_lshr_b32 s89, s3, 2
    v_lshrrev_b32 v6, 2, v3
    v_lshl_add_u32 v6, v4, 3, v6
    v_and_b32 v7, 3, v3
    v_lshlrev_b32 v7, 3, v7
    v_lshl_add_u32 v5, v6, 6, v7
    s_and_b32 s90, s88, 1
    s_lshl_b32 s90, s90, 5
    s_lshr_b32 s91, s88, 1
    s_mul_i32 s91, s91, 36864
    s_add_u32 s90, s90, s91
    s_mul_i32 s91, s89, 18432
    s_add_u32 s90, s90, s91
    s_add_u32 s90, s90, 38656
    v_add_u32 v5, s90, v5
    ds_read_b64_tr_b16 v[160:161], v5 offset:0
    ds_read_b64_tr_b16 v[162:163], v5 offset:256
    ds_read_b64_tr_b16 v[164:165], v5 offset:2048
    ds_read_b64_tr_b16 v[166:167], v5 offset:2304
    ds_read_b64_tr_b16 v[168:169], v5 offset:4096
    ds_read_b64_tr_b16 v[170:171], v5 offset:4352
    ds_read_b64_tr_b16 v[172:173], v5 offset:6144
    ds_read_b64_tr_b16 v[174:175], v5 offset:6400
    ds_read_b64_tr_b16 v[176:177], v5 offset:8192
    ds_read_b64_tr_b16 v[178:179], v5 offset:8448
    ds_read_b64_tr_b16 v[180:181], v5 offset:10240
    ds_read_b64_tr_b16 v[182:183], v5 offset:10496
    ds_read_b64_tr_b16 v[184:185], v5 offset:12288
    ds_read_b64_tr_b16 v[186:187], v5 offset:12544
    ds_read_b64_tr_b16 v[188:189], v5 offset:14336
    ds_read_b64_tr_b16 v[190:191], v5 offset:14592
    ds_read_b64_tr_b16 v[192:193], v5 offset:16384
    ds_read_b64_tr_b16 v[194:195], v5 offset:16640
    v_mul_u32_u24 v5, 1152, v6
    v_add_u32 v5, v5, v7
    s_lshl_b32 s90, s3, 5
    s_add_u32 s90, s90, 112384
    v_add_u32 v5, s90, v5
    ds_read_b64_tr_b16 v[196:197], v5 offset:0
    ds_read_b64_tr_b16 v[198:199], v5 offset:4608
    ds_read_b64_tr_b16 v[200:201], v5 offset:256
    ds_read_b64_tr_b16 v[202:203], v5 offset:4864
    ds_read_b64_tr_b16 v[204:205], v5 offset:512
    ds_read_b64_tr_b16 v[206:207], v5 offset:5120
    ds_read_b64_tr_b16 v[208:209], v5 offset:768
    ds_read_b64_tr_b16 v[210:211], v5 offset:5376
    ds_read_b64_tr_b16 v[212:213], v5 offset:1024
    ds_read_b64_tr_b16 v[214:215], v5 offset:5632
    s_mul_i32 s90, s3, 72
    v_add_u32 v5, s90, v2
    v_lshlrev_b32 v6, 4, v5
    s_and_b32 s90, s2, 7
    s_lshl_b32 s90, s90, 1
    s_bfe_u32 s91, s2, 0x10003
    s_add_u32 s90, s90, s91
    s_mul_i32 s90, s90, 9216
    s_add_u32 s90, s90, 0x200000
    v_cmp_gt_u32 vcc, 8, v2
    s_nop 1
    v_cndmask_b32 v7, 0, v6, vcc
    v_add_u32 v7, 1024, v7
    v_cndmask_b32 v7, v6, v7, vcc
    v_lshlrev_b32 v5, 1, v5
    s_sleep 2
    s_mov_b32 s96, 0
    buffer_load_dwordx4 v[232:235], v6, s[20:23], s90 offen sc1
    buffer_load_dwordx4 v[236:239], v7, s[20:23], s90 offen sc1
    s_sleep 4
L_pH_84:
    buffer_load_dwordx4 v[240:243], v6, s[20:23], s90 offen sc1
    buffer_load_dwordx4 v[244:247], v7, s[20:23], s90 offen sc1
    s_waitcnt vmcnt(2)
    v_max_u32 v16, v232, v233
    v_max3_u32 v16, v16, v234, v235
    v_max3_u32 v16, v16, v236, v237
    v_max3_u32 v16, v16, v238, v239
    v_cmp_eq_u32 vcc, -1, v16
    s_cbranch_vccz L_pHa_85
    buffer_load_dwordx4 v[232:235], v6, s[20:23], s90 offen sc1
    buffer_load_dwordx4 v[236:239], v7, s[20:23], s90 offen sc1
    s_waitcnt vmcnt(2)
    v_max_u32 v16, v240, v241
    v_max3_u32 v16, v16, v242, v243
    v_max3_u32 v16, v16, v244, v245
    v_max3_u32 v16, v16, v246, v247
    v_cmp_eq_u32 vcc, -1, v16
    s_cbranch_vccz L_pHb_86
    s_add_u32 s96, s96, 1
    s_cmp_lt_u32 s96, 0x40000
    s_cbranch_scc1 L_pH_84
L_pHa_85:
    ds_write_b16_d16_hi v5, v232 offset:5504
    ds_write_b16_d16_hi v5, v233 offset:6816
    ds_write_b16_d16_hi v5, v234 offset:8128
    ds_write_b16_d16_hi v5, v235 offset:9440
    s_mov_b64 exec, 0xff
    ds_write_b16_d16_hi v5, v236 offset:5632
    ds_write_b16_d16_hi v5, v237 offset:6944
    ds_write_b16_d16_hi v5, v238 offset:8256
    ds_write_b16_d16_hi v5, v239 offset:9568
    s_mov_b64 exec, -1
    s_branch L_pHx_87
L_pHb_86:
    ds_write_b16_d16_hi v5, v240 offset:5504
    ds_write_b16_d16_hi v5, v241 offset:6816
    ds_write_b16_d16_hi v5, v242 offset:8128
    ds_write_b16_d16_hi v5, v243 offset:9440
    s_mov_b64 exec, 0xff
    ds_write_b16_d16_hi v5, v244 offset:5632
    ds_write_b16_d16_hi v5, v245 offset:6944
    ds_write_b16_d16_hi v5, v246 offset:8256
    ds_write_b16_d16_hi v5, v247 offset:9568
    s_mov_b64 exec, -1
L_pHx_87:
    s_waitcnt lgkmcnt(0)
    s_barrier
    v_min_u32 v5, 4, v3
    v_mul_u32_u24 v5, 1312, v5
    v_lshl_add_u32 v5, v4, 4, v5
    s_mul_i32 s90, s89, 576
    v_add_u32 v5, s90, v5
    ds_read_b128 v[8:11], v5 offset:5504
    ds_read_b128 v[12:15], v5 offset:5568
    ds_read_b128 v[16:19], v5 offset:5632
    ds_read_b128 v[20:23], v5 offset:5696
    ds_read_b128 v[24:27], v5 offset:5760
    ds_read_b128 v[28:31], v5 offset:5824
    ds_read_b128 v[32:35], v5 offset:5888
    ds_read_b128 v[36:39], v5 offset:5952
    ds_read_b128 v[40:43], v5 offset:6016
    s_lshl_b32 s90, s3, 9
    v_lshlrev_b32 v6, 4, v2
    v_add_u32 v6, s90, v6
    s_waitcnt lgkmcnt(0)
    v_mfma_f32_16x16x32_bf16 v[44:47], v[8:11], v[160:163], 0
    v_mfma_f32_16x16x32_bf16 v[44:47], v[12:15], v[164:167], v[44:47]
    v_mfma_f32_16x16x32_bf16 v[44:47], v[16:19], v[168:171], v[44:47]
    v_mfma_f32_16x16x32_bf16 v[44:47], v[20:23], v[172:175], v[44:47]
    v_mfma_f32_16x16x32_bf16 v[44:47], v[24:27], v[176:179], v[44:47]
    v_mfma_f32_16x16x32_bf16 v[44:47], v[28:31], v[180:183], v[44:47]
    v_mfma_f32_16x16x32_bf16 v[44:47], v[32:35], v[184:187], v[44:47]
    v_mfma_f32_16x16x32_bf16 v[44:47], v[36:39], v[188:191], v[44:47]
    v_mfma_f32_16x16x32_bf16 v[44:47], v[40:43], v[192:195], v[44:47]
    s_cmp_eq_u32 s88, 0
    s_cbranch_scc0 L_nost_88
    v_mfma_f32_16x16x32_bf16 v[48:51], v[8:11], v[8:11], 0
    v_mfma_f32_16x16x32_bf16 v[48:51], v[12:15], v[12:15], v[48:51]
    v_mfma_f32_16x16x32_bf16 v[48:51], v[16:19], v[16:19], v[48:51]
    v_mfma_f32_16x16x32_bf16 v[48:51], v[20:23], v[20:23], v[48:51]
    v_mfma_f32_16x16x32_bf16 v[48:51], v[24:27], v[24:27], v[48:51]
    v_mfma_f32_16x16x32_bf16 v[48:51], v[28:31], v[28:31], v[48:51]
    v_mfma_f32_16x16x32_bf16 v[48:51], v[32:35], v[32:35], v[48:51]
    v_mfma_f32_16x16x32_bf16 v[48:51], v[36:39], v[36:39], v[48:51]
    v_mfma_f32_16x16x32_bf16 v[48:51], v[40:43], v[40:43], v[48:51]
    s_lshl_b32 s90, s89, 9
    v_lshlrev_b32 v7, 4, v2
    v_add_u32 v7, s90, v7
    s_mov_b32 exec_lo, -1
    s_mov_b32 exec_hi, 0
    s_nop 2
    ds_write_b128 v7, v[48:51] offset:16160
    s_mov_b64 exec, -1
L_nost_88:
    s_mov_b32 exec_lo, -1
    s_mov_b32 exec_hi, 0
    s_nop 3
    ds_write_b128 v6, v[44:47] offset:12064
    s_mov_b64 exec, -1
    s_waitcnt lgkmcnt(0)
    s_barrier
    s_cmp_lt_u32 s3, 2
    s_cbranch_scc0 L_g_89
    v_lshlrev_b32 v5, 2, v2
    s_lshl_b32 s90, s3, 9
    v_add_u32 v5, s90, v5
    v_lshrrev_b32 v6, 2, v2
    v_lshlrev_b32 v6, 4, v6
    v_add_u32 v6, s90, v6
    v_and_b32 v7, 3, v2
    v_mul_u32_u24 v8, 20, v7
    v_lshlrev_b32 v9, 4, v7
    ds_read_b32 v10, v5 offset:12064
    ds_read_b32 v11, v5 offset:14112
    ds_read_b32 v12, v5 offset:13088
    ds_read_b32 v13, v5 offset:15136
    ds_read_b32 v14, v6 offset:12320
    ds_read_b32 v15, v6 offset:14368
    ds_read_b32 v16, v6 offset:13344
    ds_read_b32 v17, v6 offset:15392
    ds_read_b32 v18, v8 offset:16160
    ds_read_b32 v19, v8 offset:16672
    ds_read_b32 v20, v9 offset:16416
    ds_read_b32 v21, v9 offset:16928
    s_waitcnt lgkmcnt(0)
    v_add_f32 v18, v18, v19
    v_add_f32 v20, v20, v21
    v_mul_f32 v20, 0x3ae38e39, v20
    v_mul_f32 v18, 0x3ae38e39, v18
    v_fma_f32 v18, -v20, v20, v18
    v_max_f32 v18, 0, v18
    v_cvt_pk_bf16_f32 v18, v18, v18
    v_and_b32 v18, 0xffff0000, v18
    v_add_f32 v18, 0x3727c5ac, v18
    v_cvt_pk_bf16_f32 v18, v18, v18
    v_and_b32 v18, 0xffff0000, v18
    v_sqrt_f32 v18, v18
    v_cvt_pk_bf16_f32 v20, v20, v20
    v_and_b32 v20, 0xffff0000, v20
    v_cvt_pk_bf16_f32 v18, v18, v18
    v_and_b32 v18, 0xffff0000, v18
    v_rcp_f32 v18, v18
    v_add_f32 v10, v10, v11
    v_add_f32 v12, v12, v13
    v_add_f32 v14, v14, v15
    v_add_f32 v16, v16, v17
    v_fma_f32 v10, -v20, v14, v10
    v_fma_f32 v12, -v20, v16, v12
    v_mul_f32 v8, v10, v18
    v_mul_f32 v10, v12, v18
    v_cvt_pk_bf16_f32 v8, v8, v8
    v_and_b32 v8, 0xffff0000, v8
    v_cvt_pk_bf16_f32 v10, v10, v10
    v_and_b32 v10, 0xffff0000, v10
    v_mul_f32 v9, v8, v8
    v_mov_b32 v11, 1.0
    v_fmac_f32 v11, 0x3d372713, v9
    v_mul_f32 v11, v11, v8
    v_mul_f32 v11, 0xc0135761, v11
    v_exp_f32 v11, v11
    s_nop 0
    v_add_f32 v11, 1.0, v11
    v_rcp_f32 v11, v11
    s_nop 0
    v_mul_f32 v8, v8, v11
    v_cvt_pk_bf16_f32 v8, v8, v8
    v_and_b32 v8, 0xffff0000, v8
    v_mul_f32 v8, v8, v10
    v_cvt_pk_bf16_f32 v8, v8, v8
    v_lshlrev_b32 v5, 6, v7
    v_lshrrev_b32 v6, 2, v2
    v_lshl_add_u32 v5, v6, 1, v5
    s_lshl_b32 s90, s3, 5
    v_add_u32 v5, s90, v5
    ds_write_b16 v5, v8 offset:17184
L_g_89:
    v_and_b32 v5, 3, v2
    v_lshlrev_b32 v5, 6, v5
    v_lshl_add_u32 v5, v4, 4, v5
    s_mul_i32 s90, s53, 9216
    s_lshl_b32 s91, s3, 8
    s_add_u32 s90, s90, s91
    s_add_u32 s90, s90, 0x90000
    v_lshlrev_b32 v6, 4, v2
    s_waitcnt lgkmcnt(0)
    s_barrier
    ds_read_b128 v[8:11], v5 offset:17184
    s_waitcnt lgkmcnt(0)
    v_mfma_f32_16x16x32_bf16 v[40:43], v[8:11], v[196:199], 0
    v_mfma_f32_16x16x32_bf16 v[44:47], v[8:11], v[200:203], 0
    v_mfma_f32_16x16x32_bf16 v[48:51], v[8:11], v[204:207], 0
    v_mfma_f32_16x16x32_bf16 v[52:55], v[8:11], v[208:211], 0
    v_mfma_f32_16x16x32_bf16 v[56:59], v[8:11], v[212:215], 0
    s_nop 3
    v_min_u32 v40, s59, v40
    v_min_u32 v41, s59, v41
    v_min_u32 v42, s59, v42
    v_min_u32 v43, s59, v43
    v_min_u32 v44, s59, v44
    v_min_u32 v45, s59, v45
    v_min_u32 v46, s59, v46
    v_min_u32 v47, s59, v47
    v_min_u32 v48, s59, v48
    v_min_u32 v49, s59, v49
    v_min_u32 v50, s59, v50
    v_min_u32 v51, s59, v51
    v_min_u32 v52, s59, v52
    v_min_u32 v53, s59, v53
    v_min_u32 v54, s59, v54
    v_min_u32 v55, s59, v55
    v_min_u32 v56, s59, v56
    v_min_u32 v57, s59, v57
    v_min_u32 v58, s59, v58
    v_min_u32 v59, s59, v59
    s_mov_b64 exec, 0xffff
    buffer_store_dwordx4 v[40:43], v6, s[20:23], s90 offen sc1
    s_add_u32 s90, s90, 2048
    buffer_store_dwordx4 v[44:47], v6, s[20:23], s90 offen sc1
    s_add_u32 s90, s90, 2048
    buffer_store_dwordx4 v[48:51], v6, s[20:23], s90 offen sc1
    s_add_u32 s90, s90, 2048
    buffer_store_dwordx4 v[52:55], v6, s[20:23], s90 offen sc1
    s_add_u32 s90, s90, 2048
    s_cmp_lt_u32 s3, 4
    s_cbranch_scc0 L_z_90
    buffer_store_dwordx4 v[56:59], v6, s[20:23], s90 offen sc1
    s_add_u32 s90, s90, 2048
L_z_90:
    s_mov_b64 exec, -1
    s_cmp_eq_u32 s3, 7
    s_cbranch_scc0 L_fin
    v_lshrrev_b32 v5, 2, v2
    v_and_b32 v6, 3, v2
    v_mul_u32_u24 v7, 9216, v5
    v_lshl_add_u32 v7, v6, 4, v7
    s_lshl_b32 s90, s53, 6
    s_add_u32 s91, s90, 0x90000
    s_lshl_b32 s90, s53, 3
    v_lshlrev_b32 v44, 1, v6
    v_add_u32 v44, s90, v44
    ds_read_u16 v48, v44 offset:5504
    ds_read_u16 v49, v44 offset:6816
    ds_read_u16 v50, v44 offset:8128
    ds_read_u16 v51, v44 offset:9440
    s_sleep 8
    s_mov_b32 s96, 0
    s_mov_b32 s92, s91
    buffer_load_dwordx4 v[60:63], v7, s[20:23], s92 offen sc1
    s_add_u32 s92, s92, 147456
    buffer_load_dwordx4 v[64:67], v7, s[20:23], s92 offen sc1
    s_add_u32 s92, s92, 147456
    buffer_load_dwordx4 v[68:71], v7, s[20:23], s92 offen sc1
    s_add_u32 s92, s92, 147456
    buffer_load_dwordx4 v[72:75], v7, s[20:23], s92 offen sc1
    s_add_u32 s92, s92, 147456
    buffer_load_dwordx4 v[76:79], v7, s[20:23], s92 offen sc1
    s_add_u32 s92, s92, 147456
    buffer_load_dwordx4 v[80:83], v7, s[20:23], s92 offen sc1
    s_add_u32 s92, s92, 147456
    buffer_load_dwordx4 v[84:87], v7, s[20:23], s92 offen sc1
    s_add_u32 s92, s92, 147456
    buffer_load_dwordx4 v[88:91], v7, s[20:23], s92 offen sc1
    s_add_u32 s92, s92, 147456
    buffer_load_dwordx4 v[92:95], v7, s[20:23], s92 offen sc1
    s_sleep 4
L_pZ_91:
    s_mov_b32 s92, s91
    buffer_load_dwordx4 v[96:99], v7, s[20:23], s92 offen sc1
    s_add_u32 s92, s92, 147456
    buffer_load_dwordx4 v[100:103], v7, s[20:23], s92 offen sc1
    s_add_u32 s92, s92, 147456
    buffer_load_dwordx4 v[104:107], v7, s[20:23], s92 offen sc1
    s_add_u32 s92, s92, 147456
    buffer_load_dwordx4 v[108:111], v7, s[20:23], s92 offen sc1
    s_add_u32 s92, s92, 147456
    buffer_load_dwordx4 v[112:115], v7, s[20:23], s92 offen sc1
    s_add_u32 s92, s92, 147456
    buffer_load_dwordx4 v[116:119], v7, s[20:23], s92 offen sc1
    s_add_u32 s92, s92, 147456
    buffer_load_dwordx4 v[120:123], v7, s[20:23], s92 offen sc1
    s_add_u32 s92, s92, 147456
    buffer_load_dwordx4 v[124:127], v7, s[20:23], s92 offen sc1
    s_add_u32 s92, s92, 147456
    buffer_load_dwordx4 v[128:131], v7, s[20:23], s92 offen sc1
    s_waitcnt vmcnt(9)
    v_max_u32 v45, v60, v61
    v_max3_u32 v45, v45, v62, v63
    v_max3_u32 v45, v45, v64, v65
    v_max3_u32 v45, v45, v66, v67
    v_max3_u32 v45, v45, v68, v69
    v_max3_u32 v45, v45, v70, v71
    v_max3_u32 v45, v45, v72, v73
    v_max3_u32 v45, v45, v74, v75
    v_max3_u32 v45, v45, v76, v77
    v_max3_u32 v45, v45, v78, v79
    v_max3_u32 v45, v45, v80, v81
    v_max3_u32 v45, v45, v82, v83
    v_max3_u32 v45, v45, v84, v85
    v_max3_u32 v45, v45, v86, v87
    v_max3_u32 v45, v45, v88, v89
    v_max3_u32 v45, v45, v90, v91
    v_max3_u32 v45, v45, v92, v93
    v_max3_u32 v45, v45, v94, v95
    v_cmp_eq_u32 vcc, -1, v45
    s_cbranch_vccz L_pZa_92
    s_mov_b32 s92, s91
    buffer_load_dwordx4 v[60:63], v7, s[20:23], s92 offen sc1
    s_add_u32 s92, s92, 147456
    buffer_load_dwordx4 v[64:67], v7, s[20:23], s92 offen sc1
    s_add_u32 s92, s92, 147456
    buffer_load_dwordx4 v[68:71], v7, s[20:23], s92 offen sc1
    s_add_u32 s92, s92, 147456
    buffer_load_dwordx4 v[72:75], v7, s[20:23], s92 offen sc1
    s_add_u32 s92, s92, 147456
    buffer_load_dwordx4 v[76:79], v7, s[20:23], s92 offen sc1
    s_add_u32 s92, s92, 147456
    buffer_load_dwordx4 v[80:83], v7, s[20:23], s92 offen sc1
    s_add_u32 s92, s92, 147456
    buffer_load_dwordx4 v[84:87], v7, s[20:23], s92 offen sc1
    s_add_u32 s92, s92, 147456
    buffer_load_dwordx4 v[88:91], v7, s[20:23], s92 offen sc1
    s_add_u32 s92, s92, 147456
    buffer_load_dwordx4 v[92:95], v7, s[20:23], s92 offen sc1
    s_waitcnt vmcnt(9)
    v_max_u32 v45, v96, v97
    v_max3_u32 v45, v45, v98, v99
    v_max3_u32 v45, v45, v100, v101
    v_max3_u32 v45, v45, v102, v103
    v_max3_u32 v45, v45, v104, v105
    v_max3_u32 v45, v45, v106, v107
    v_max3_u32 v45, v45, v108, v109
    v_max3_u32 v45, v45, v110, v111
    v_max3_u32 v45, v45, v112, v113
    v_max3_u32 v45, v45, v114, v115
    v_max3_u32 v45, v45, v116, v117
    v_max3_u32 v45, v45, v118, v119
    v_max3_u32 v45, v45, v120, v121
    v_max3_u32 v45, v45, v122, v123
    v_max3_u32 v45, v45, v124, v125
    v_max3_u32 v45, v45, v126, v127
    v_max3_u32 v45, v45, v128, v129
    v_max3_u32 v45, v45, v130, v131
    v_cmp_eq_u32 vcc, -1, v45
    s_cbranch_vccz L_pZb_93
    s_add_u32 s96, s96, 1
    s_cmp_lt_u32 s96, 0x40000
    s_cbranch_scc1 L_pZ_91
L_pZa_92:
    v_add_f32 v8, v60, v64
    v_add_f32 v9, v61, v65
    v_add_f32 v10, v62, v66
    v_add_f32 v11, v63, v67
    v_add_f32 v8, v8, v68
    v_add_f32 v9, v9, v69
    v_add_f32 v10, v10, v70
    v_add_f32 v11, v11, v71
    v_add_f32 v8, v8, v72
    v_add_f32 v9, v9, v73
    v_add_f32 v10, v10, v74
    v_add_f32 v11, v11, v75
    v_add_f32 v8, v8, v76
    v_add_f32 v9, v9, v77
    v_add_f32 v10, v10, v78
    v_add_f32 v11, v11, v79
    v_add_f32 v8, v8, v80
    v_add_f32 v9, v9, v81
    v_add_f32 v10, v10, v82
    v_add_f32 v11, v11, v83
    v_add_f32 v8, v8, v84
    v_add_f32 v9, v9, v85
    v_add_f32 v10, v10, v86
    v_add_f32 v11, v11, v87
    v_add_f32 v8, v8, v88
    v_add_f32 v9, v9, v89
    v_add_f32 v10, v10, v90
    v_add_f32 v11, v11, v91
    v_add_f32 v8, v8, v92
    v_add_f32 v9, v9, v93
    v_add_f32 v10, v10, v94
    v_add_f32 v11, v11, v95
    s_branch L_pZx_94
L_pZb_93:
    v_add_f32 v8, v96, v100
    v_add_f32 v9, v97, v101
    v_add_f32 v10, v98, v102
    v_add_f32 v11, v99, v103
    v_add_f32 v8, v8, v104
    v_add_f32 v9, v9, v105
    v_add_f32 v10, v10, v106
    v_add_f32 v11, v11, v107
    v_add_f32 v8, v8, v108
    v_add_f32 v9, v9, v109
    v_add_f32 v10, v10, v110
    v_add_f32 v11, v11, v111
    v_add_f32 v8, v8, v112
    v_add_f32 v9, v9, v113
    v_add_f32 v10, v10, v114
    v_add_f32 v11, v11, v115
    v_add_f32 v8, v8, v116
    v_add_f32 v9, v9, v117
    v_add_f32 v10, v10, v118
    v_add_f32 v11, v11, v119
    v_add_f32 v8, v8, v120
    v_add_f32 v9, v9, v121
    v_add_f32 v10, v10, v122
    v_add_f32 v11, v11, v123
    v_add_f32 v8, v8, v124
    v_add_f32 v9, v9, v125
    v_add_f32 v10, v10, v126
    v_add_f32 v11, v11, v127
    v_add_f32 v8, v8, v128
    v_add_f32 v9, v9, v129
    v_add_f32 v10, v10, v130
    v_add_f32 v11, v11, v131
L_pZx_94:
    v_add_f32_dpp v8, v8, v8 row_ror:4 row_mask:0xf bank_mask:0xf
    v_add_f32_dpp v9, v9, v9 row_ror:4 row_mask:0xf bank_mask:0xf
    v_add_f32_dpp v10, v10, v10 row_ror:4 row_mask:0xf bank_mask:0xf
    v_add_f32_dpp v11, v11, v11 row_ror:4 row_mask:0xf bank_mask:0xf
    v_add_f32_dpp v8, v8, v8 row_ror:8 row_mask:0xf bank_mask:0xf
    v_add_f32_dpp v9, v9, v9 row_ror:8 row_mask:0xf bank_mask:0xf
    v_add_f32_dpp v10, v10, v10 row_ror:8 row_mask:0xf bank_mask:0xf
    v_add_f32_dpp v11, v11, v11 row_ror:8 row_mask:0xf bank_mask:0xf
    v_mov_b32 v16, v8
    v_mov_b32 v17, v9
    v_mov_b32 v18, v10
    v_mov_b32 v19, v11
    v_permlane16_swap_b32 v8, v16
    v_permlane16_swap_b32 v9, v17
    v_permlane16_swap_b32 v10, v18
    v_permlane16_swap_b32 v11, v19
    v_add_f32 v8, v8, v16
    v_add_f32 v9, v9, v17
    v_add_f32 v10, v10, v18
    v_add_f32 v11, v11, v19
    v_mov_b32 v16, v8
    v_mov_b32 v17, v9
    v_mov_b32 v18, v10
    v_mov_b32 v19, v11
    v_permlane32_swap_b32 v8, v16
    v_permlane32_swap_b32 v9, v17
    v_permlane32_swap_b32 v10, v18
    v_permlane32_swap_b32 v11, v19
    v_add_f32 v8, v8, v16
    v_add_f32 v9, v9, v17
    v_add_f32 v10, v10, v18
    v_add_f32 v11, v11, v19
    s_waitcnt lgkmcnt(0)
    v_cvt_pk_bf16_f32 v8, v8, v8
    v_and_b32 v8, 0xffff0000, v8
    v_cvt_pk_bf16_f32 v9, v9, v9
    v_and_b32 v9, 0xffff0000, v9
    v_cvt_pk_bf16_f32 v10, v10, v10
    v_and_b32 v10, 0xffff0000, v10
    v_cvt_pk_bf16_f32 v11, v11, v11
    v_and_b32 v11, 0xffff0000, v11
    v_lshlrev_b32 v48, 16, v48
    v_add_f32 v8, v8, v48
    v_cvt_pk_bf16_f32 v8, v8, v8
    v_lshlrev_b32 v49, 16, v49
    v_add_f32 v9, v9, v49
    v_cvt_pk_bf16_f32 v9, v9, v9
    v_lshlrev_b32 v50, 16, v50
    v_add_f32 v10, v10, v50
    v_cvt_pk_bf16_f32 v10, v10, v10
    v_lshlrev_b32 v51, 16, v51
    v_add_f32 v11, v11, v51
    v_cvt_pk_bf16_f32 v11, v11, v11
    s_mov_b64 exec, 0xf
    buffer_store_short v8, v44, s[40:43], 0 offen offset:0 sc1
    buffer_store_short v9, v44, s[40:43], 0 offen offset:1152 sc1
    buffer_store_short v10, v44, s[40:43], 0 offen offset:2304 sc1
    buffer_store_short v11, v44, s[40:43], 0 offen offset:3456 sc1
    s_mov_b64 exec, -1
L_fin:
    s_cmp_eq_u32 s53, 0
    s_cselect_b32 s88, s3, 0
    s_cmp_eq_u32 s88, 7
    s_cbranch_scc0 L_ep_95
    s_add_u32 s88, s63, 1
    v_mov_b32 v5, s88
    s_mov_b32 s89, 0x1f8000
    s_mov_b64 exec, 1
    buffer_store_dword v5, v141, s[20:23], s89 offen sc1
    s_mov_b64 exec, -1
L_ep_95:
L_end:
    s_endpgm
.section .rodata,"a"
.p2align 6
.amdhsa_kernel sequential_preLN__mha_block_cached__glu_gated_geglu__decode_kernel
  .amdhsa_next_free_vgpr 256
  .amdhsa_next_free_sgpr 102
  .amdhsa_accum_offset 256
  .amdhsa_group_segment_fixed_size 0
  .amdhsa_kernarg_size 96
  .amdhsa_user_sgpr_count 2
  .amdhsa_user_sgpr_kernarg_segment_ptr 1
  .amdhsa_system_sgpr_workgroup_id_x 1
  .amdhsa_float_denorm_mode_32 3
.end_amdhsa_kernel
```
